```python
import torch

def _softmax(x, axis=-1):
    return torch.softmax(x, dim=axis)

def _gelu(x):
    return torch.nn.functional.gelu(x, approximate='tanh')

def _silu(x):
    return torch.nn.functional.silu(x)

def _sigmoid(x):
    return torch.sigmoid(x)

def _layernorm(x, axis=-1, eps=1e-05):
    m = x.mean(dim=axis, keepdim=True)
    v = x.var(dim=axis, keepdim=True, unbiased=False)
    return (x - m) / torch.sqrt(v + eps)

def _scatter_add(tgt, idx, src, axis=0):
    return tgt.clone().index_add_(axis, idx, src)

def _segment_sum(src, seg, n):
    out = torch.zeros((n,) + src.shape[1:], dtype=src.dtype)
    return out.index_add_(0, seg, src)

def _pad(x, pw):
    flat = tuple((v for pair in reversed(pw) for v in pair))
    return torch.nn.functional.pad(x, flat)
kernel_name = 'adaLN_cond__ssm_conv_h3__dense_activation_silu__prompt'

def setup_inputs():

    _w = lambda a: (lambda t: t.to(torch.bfloat16) if t.is_floating_point() else t)(torch.as_tensor(a))

    def _A_setup():
        B, S, D = (1, 2048, 512)
        ks = 4
        return {'q': _w((lambda *s: torch.randn(*s, dtype=torch.bfloat16) * 0.05)(B, S, D)), 'k': _w((lambda *s: torch.randn(*s, dtype=torch.bfloat16) * 0.8)(B, S, D)), 'v': _w((lambda *s: torch.randn(*s, dtype=torch.bfloat16) * 0.8)(B, S, D)), 'shift_k': _w((lambda *s: torch.randn(*s, dtype=torch.bfloat16) * 0.8)(D, ks) * 0.5), 'ssm_k': _w((lambda *s: torch.randn(*s, dtype=torch.bfloat16) * 0.8)(D, S) * (1.0 / S ** 0.5)), 'ssm_D': _w((lambda *s: torch.randn(*s, dtype=torch.bfloat16) * 0.8)(D))}
    _A_in = _A_setup()

    def _B_setup():
        B, S, D, F = (1, 2048, 512, 1792)
        return {'x': _w((lambda *s: torch.randn(*s, dtype=torch.bfloat16) * 0.05)(B, S, D)), 'w1': _w((lambda *s: torch.randn(*s, dtype=torch.bfloat16) * 3.2)(D, F) * D ** (-0.5)), 'w2': _w((lambda *s: torch.randn(*s, dtype=torch.bfloat16) * 0.8)(F, D) * F ** (-0.5))}
    _B_in = _B_setup()
    return {'A_q': _A_in['q'], 'A_k': _A_in['k'], 'A_v': _A_in['v'], 'A_shift_k': _A_in['shift_k'], 'A_ssm_k': _A_in['ssm_k'], 'A_ssm_D': _A_in['ssm_D'], 'B_x': _B_in['x'], 'B_w1': _B_in['w1'], 'B_w2': _B_in['w2'], 'c': _w((lambda *s: torch.randn(*s, dtype=torch.bfloat16) * 0.2)(1, 512) * 8.0), 'w_mod': _w((lambda *s: torch.randn(*s, dtype=torch.bfloat16) * 0.2)(512, 6 * 512) * 512 ** (-0.5) * 8.0)}

def reference(A_q, A_k, A_v, A_shift_k, A_ssm_k, A_ssm_D, B_x, B_w1, B_w2, c, w_mod):

    def _A_ref(q, k, v, shift_k, ssm_k, ssm_D):
        B, S, D = q.shape
        ks = shift_k.shape[-1]
        k_pad = _pad(k, ((0, 0), (ks - 1, 0), (0, 0)))
        k_shift = torch.zeros_like(k)
        for t in range(ks):
            k_shift = k_shift + k_pad[:, t:t + S, :] * shift_k[:, ks - 1 - t][None, None, :]
        kv = k_shift * v
        L = 2 * S
        kv_pad = _pad(kv, ((0, 0), (0, S), (0, 0)))
        kf_pad = _pad(ssm_k, ((0, 0), (0, S)))
        kv_f = (lambda x, axes=(-2, -1): torch.fft.rfft2(x.float(), dim=axes))(kv_pad[:, None, :, :], axes=(1, 2))
        kf_f = (lambda x, axes=(-2, -1): torch.fft.rfft2(x.float(), dim=axes))(kf_pad[:, None, :], axes=(1, 2))
        kf_f = (lambda x, *d: x.permute(*d))(kf_f, 1, 2, 0)
        y_f = kv_f * kf_f[None, :, :, :]
        y = (lambda x, s, axes=(-2, -1): torch.fft.irfft2(x, s=s, dim=axes).to(torch.bfloat16))(y_f, (1, L), axes=(1, 2))[:, 0, :S, :]
        y = y + kv * ssm_D[None, None, :]
        return q * y

    def _B_ref(x, w1, w2):
        h = torch.einsum('bsd,df->bsf', x, w1)
        h = _silu(h)
        out = torch.einsum('bsf,fd->bsd', h, w2)
        return out
    x = A_q
    mod = (_silu(c) @ w_mod).reshape(c.shape[0], 6, 1, -1)
    sa, ca, ga, sb, cb, gb = (mod[:, 0].clone(), mod[:, 1].clone(), mod[:, 2].clone(), mod[:, 3].clone(), mod[:, 4].clone(), mod[:, 5].clone())
    h = _layernorm(x, axis=-1) * (1 + ca) + sa
    x = x + ga * _A_ref(h, A_k, A_v, A_shift_k, A_ssm_k, A_ssm_D)
    h = _layernorm(x, axis=-1) * (1 + cb) + sb
    x = x + gb * _B_ref(h, B_w1, B_w2)
    return x
```

```asm
; @launch grid=(256,1,1) block=(256,1,1) lds=163840
.amdgcn_target "amdgcn-amd-amdhsa--gfx950"
.text
.globl adaLN_cond__ssm_conv_h3__dense_activation_silu__prompt_kernel
.p2align 8
.type adaLN_cond__ssm_conv_h3__dense_activation_silu__prompt_kernel,@function
adaLN_cond__ssm_conv_h3__dense_activation_silu__prompt_kernel:
    s_cmp_ge_u32 s2, 256
    s_cbranch_scc1 L_end
    s_load_dwordx2 s[4:5], s[0:1], 0
    s_load_dwordx2 s[44:45], s[0:1], 72
    s_load_dwordx2 s[8:9], s[0:1], 8
    s_load_dwordx2 s[12:13], s[0:1], 16
    s_load_dwordx2 s[40:41], s[0:1], 24
    s_load_dwordx2 s[36:37], s[0:1], 104
    s_getpc_b64 s[70:71]
L_pc:
    s_bfe_u32 s65, s2, 0x30003
    s_lshl_b32 s65, s65, 13
    v_and_b32 v254, 63, v0
    v_lshlrev_b32 v254, 7, v254
    v_add_u32 v255, s65, v254
    v_cmp_gt_u32 vcc, 64, v0
    s_nop 1
    v_cndmask_b32 v254, v254, v255, vcc
    v_min_u32 v254, L_end-L_pc, v254
    v_cmp_gt_u32 vcc, 64, v0
    s_nop 0
    s_and_saveexec_b64 s[66:67], vcc
    s_cbranch_execz L_nopf
    global_load_dword v255, v254, s[70:71]
L_nopf:
    s_mov_b64 exec, -1
    v_lshrrev_b32 v1, 6, v0
    v_and_b32 v2, 63, v0
    v_readfirstlane_b32 s3, v1
    s_mov_b32 s6, 2097152
    s_mov_b32 s7, 0x20000
    s_mov_b32 s46, 1024
    s_mov_b32 s47, 0x20000
    s_mov_b32 s10, 2097152
    s_mov_b32 s11, 0x20000
    s_mov_b32 s14, 2097152
    s_mov_b32 s15, 0x20000
    s_mov_b32 s42, 4096
    s_mov_b32 s43, 0x20000
    s_mov_b32 s38, 18874368
    s_mov_b32 s39, 0x20000
    s_lshr_b32 s54, s2, 1
    s_and_b32 s55, s2, 1
    s_lshl_b32 s55, s55, 2
    s_add_u32 s55, s55, s3
    s_lshl_b32 s55, s55, 5
    v_and_b32 v3, 31, v0
    v_add_u32 v5, s55, v3
    v_bfe_u32 v4, v0, 5, 1
    v_lshlrev_b32 v6, 2, v5
    v_lshl_add_u32 v6, v4, 10, v6
    s_lshl_b32 s56, s54, 14
    s_add_u32 s57, s56, 4096
    s_add_u32 s58, s56, 8192
    s_add_u32 s59, s56, 12288
    s_sub_u32 s60, s56, 3072
    v_add_u32 v8, s60, v6
    v_add_u32 v9, 1024, v8
    v_add_u32 v57, 2048, v8
    v_lshlrev_b32 v7, 4, v5
    s_lshl_b32 s61, s2, 2
    s_add_u32 s61, s61, s3
    s_lshl_b32 s62, s61, 11
    v_lshlrev_b32 v58, 4, v2
    s_mul_i32 s63, s2, 1366
    s_lshr_b32 s63, s63, 16
    v_and_b32 v59, 127, v0
    v_lshlrev_b32 v59, 1, v59
    s_lshl_b32 s66, s63, 8
    v_lshlrev_b32 v252, 11, v2
    s_lshl_b32 s65, s2, 7
    v_mov_b32 v253, 16384
    v_cmp_eq_u32 vcc, 4, v2
    s_add_u32 s65, s65, 17825792
    s_nop 0
    v_cndmask_b32 v252, v252, v253, vcc
    v_mov_b32 v253, 163840
    v_cmp_eq_u32 vcc, 3, v2
    s_nop 1
    v_cndmask_b32 v252, v252, v253, vcc
    v_mov_b32 v253, 0
    s_waitcnt lgkmcnt(0)
    s_cmp_eq_u32 s3, 3
    s_cbranch_scc0 L_w3_1
    s_mov_b64 exec, 0x18
    buffer_store_dword v253, v252, s[36:39], s65 offen sc1
    s_mov_b64 exec, -1
L_w3_1:
    buffer_load_dwordx4 v[48:51], v58, s[4:7], s62 offen
    buffer_load_dwordx4 v[52:55], v58, s[4:7], s62 offen offset:1024
    buffer_load_ushort v56, v59, s[44:47], s66 offen
    buffer_load_dword v10, v8, s[8:11], 0 offen
    buffer_load_dword v11, v9, s[8:11], 0 offen
    buffer_load_dword v12, v57, s[8:11], 0 offen
    buffer_load_dword v13, v6, s[8:11], s56 offen offset:0
    buffer_load_dword v14, v6, s[8:11], s56 offen offset:1024
    buffer_load_dword v15, v6, s[8:11], s56 offen offset:2048
    buffer_load_dword v16, v6, s[8:11], s56 offen offset:3072
    buffer_load_dword v17, v6, s[8:11], s57 offen offset:0
    buffer_load_dword v18, v6, s[8:11], s57 offen offset:1024
    buffer_load_dword v19, v6, s[8:11], s57 offen offset:2048
    buffer_load_dword v20, v6, s[8:11], s57 offen offset:3072
    buffer_load_dword v21, v6, s[8:11], s58 offen offset:0
    buffer_load_dword v22, v6, s[8:11], s58 offen offset:1024
    buffer_load_dword v23, v6, s[8:11], s58 offen offset:2048
    buffer_load_dword v24, v6, s[8:11], s58 offen offset:3072
    buffer_load_dword v25, v6, s[8:11], s59 offen offset:0
    buffer_load_dword v26, v6, s[8:11], s59 offen offset:1024
    buffer_load_dword v27, v6, s[8:11], s59 offen offset:2048
    buffer_load_dwordx4 v[44:47], v7, s[40:43], 0 offen
    buffer_load_dword v28, v6, s[12:15], s56 offen offset:0
    buffer_load_dword v29, v6, s[12:15], s56 offen offset:2048
    buffer_load_dword v30, v6, s[12:15], s57 offen offset:0
    buffer_load_dword v31, v6, s[12:15], s57 offen offset:2048
    buffer_load_dword v32, v6, s[12:15], s58 offen offset:0
    buffer_load_dword v33, v6, s[12:15], s58 offen offset:2048
    buffer_load_dword v34, v6, s[12:15], s59 offen offset:0
    buffer_load_dword v35, v6, s[12:15], s59 offen offset:2048
    buffer_load_dword v36, v6, s[4:7], s56 offen offset:0
    buffer_load_dword v37, v6, s[4:7], s56 offen offset:2048
    buffer_load_dword v38, v6, s[4:7], s57 offen offset:0
    buffer_load_dword v39, v6, s[4:7], s57 offen offset:2048
    buffer_load_dword v40, v6, s[4:7], s58 offen offset:0
    buffer_load_dword v41, v6, s[4:7], s58 offen offset:2048
    buffer_load_dword v42, v6, s[4:7], s59 offen offset:0
    buffer_load_dword v43, v6, s[4:7], s59 offen offset:2048
    s_load_dwordx2 s[28:29], s[0:1], 80
    s_load_dwordx2 s[16:17], s[0:1], 32
    s_load_dwordx2 s[48:49], s[0:1], 40
    s_load_dwordx2 s[20:21], s[0:1], 56
    s_load_dwordx2 s[24:25], s[0:1], 64
    s_load_dwordx2 s[32:33], s[0:1], 88
    s_mov_b32 s30, 3145728
    s_mov_b32 s31, 0x20000
    s_mov_b32 s18, 2097152
    s_mov_b32 s19, 0x20000
    s_mov_b32 s50, 1024
    s_mov_b32 s51, 0x20000
    s_mov_b32 s22, 1835008
    s_mov_b32 s23, 0x20000
    s_mov_b32 s26, 1835008
    s_mov_b32 s27, 0x20000
    s_mov_b32 s34, 2097152
    s_mov_b32 s35, 0x20000
    s_mul_i32 s64, s63, 48
    s_sub_u32 s64, s2, s64
    v_lshrrev_b32 v62, 3, v2
    v_and_b32 v61, 2, v62
    v_lshlrev_b32 v61, 5, v61
    v_and_b32 v60, 7, v2
    v_lshlrev_b32 v60, 4, v60
    v_xor_b32 v60, v60, v61
    v_mul_u32_u24 v62, 6144, v62
    v_add_u32 v60, v60, v62
    v_xor_b32 v61, 32, v60
    s_lshl_b32 s66, s63, 7
    s_lshl_b32 s67, s3, 5
    s_add_u32 s66, s66, s67
    s_mul_i32 s66, s66, 6144
    s_lshl_b32 s65, s64, 7
    s_add_u32 s66, s66, s65
    s_lshl_b32 s68, s3, 12
    s_add_u32 m0, s68, 98304
    s_waitcnt lgkmcnt(0)
    buffer_load_dwordx4 v60, s[28:31], s66 offen lds
    s_add_u32 m0, m0, 1024
    s_add_u32 s66, s66, 49152
    buffer_load_dwordx4 v61, s[28:31], s66 offen lds
    s_add_u32 m0, m0, 1024
    s_add_u32 s66, s66, 49152
    buffer_load_dwordx4 v60, s[28:31], s66 offen lds
    s_add_u32 m0, m0, 1024
    s_add_u32 s66, s66, 49152
    buffer_load_dwordx4 v61, s[28:31], s66 offen lds
    s_add_u32 s70, s36, 17826048
    s_addc_u32 s71, s37, 0
    s_load_dwordx2 s[84:85], s[70:71], 0
    s_mov_b32 s99, 0x05040100
    s_mov_b32 s100, 0x07060302
    s_mov_b32 s101, 0x3f803f80
    s_xor_b32 s1, s2, 0
    s_bfe_u32 s92, s1, 0x20001
    s_lshl_b32 s92, s92, 2
    s_lshr_b32 s98, s1, 6
    s_add_u32 s92, s92, s98
    s_bfe_u32 s93, s1, 0x30003
    s_add_u32 s94, s93, s98
    s_and_b32 s94, s94, 7
    s_and_b32 s91, s1, 1
    s_mul_i32 s88, s91, 7
    s_add_u32 s88, s88, s93
    s_add_u32 s91, s91, 14
    s_cmp_eq_u32 s93, 7
    s_cselect_b32 s88, s91, s88
    s_and_b32 s0, s1, 7
    s_lshl_b32 s0, s0, 3
    s_lshr_b32 s91, s1, 7
    s_lshl_b32 s91, s91, 2
    s_add_u32 s0, s0, s91
    s_bfe_u32 s91, s1, 0x10006
    s_add_u32 s0, s0, s91
    s_lshl_b32 s91, s98, 1
    s_add_u32 s91, s91, s93
    s_mov_b32 s91, s93
    s_cmp_ge_u32 s88, 14
    s_cselect_b32 s22, 0, s22
    s_cmp_ge_u32 s91, 7
    s_cselect_b32 s98, 7, 0
    s_sub_u32 s91, s91, s98
    s_cmp_ge_u32 s91, 7
    s_cselect_b32 s98, 7, 0
    s_sub_u32 s91, s91, s98
    s_cmp_eq_u32 s3, 2
    s_cbranch_scc0 L_noclr2
    s_lshl_b32 s68, s2, 7
    s_add_u32 s68, s68, 16908288
    v_lshlrev_b32 v64, 2, v2
    s_mov_b32 exec_hi, 0
    buffer_store_dword v253, v64, s[36:39], s68 offen sc1
    s_mov_b64 exec, -1
L_noclr2:
    v_lshrrev_b32 v64, 3, v2
    v_and_b32 v239, 2, v64
    v_lshlrev_b32 v239, 5, v239
    v_and_b32 v238, 7, v2
    v_lshlrev_b32 v238, 4, v238
    v_xor_b32 v238, v238, v239
    v_mul_u32_u24 v64, 3584, v64
    v_add_u32 v238, v238, v64
    v_xor_b32 v239, 32, v238
    s_mov_b32 s68, 917504
    v_bfe_u32 v64, v238, 6, 1
    v_mul_lo_u32 v65, v64, s68
    v_lshlrev_b32 v64, 6, v64
    v_sub_u32 v236, v65, v64
    v_sub_u32 v65, s68, v65
    v_sub_u32 v237, v65, v64
    v_add_u32 v239, 27648, v239
    v_add_u32 v240, 55296, v238
    v_add_u32 v241, 55296, v239
    v_lshrrev_b32 v64, 5, v2
    v_bfe_u32 v65, v2, 2, 2
    v_lshl_add_u32 v242, v64, 3, v65
    v_lshlrev_b32 v242, 7, v242
    v_and_b32 v65, 2, v65
    v_or_b32 v65, v65, v64
    v_bfe_u32 v64, v2, 4, 1
    v_xor_b32 v65, v65, v64
    v_lshl_add_u32 v242, v65, 5, v242
    v_and_b32 v64, 3, v2
    v_lshl_add_u32 v242, v64, 3, v242
    s_lshl_b32 s68, s3, 15
    v_add_u32 v242, s68, v242
    v_xor_b32 v243, 64, v242
    s_lshl_b32 s89, s3, 15
    v_lshrrev_b32 v64, 3, v2
    v_and_b32 v229, 2, v64
    v_lshlrev_b32 v229, 5, v229
    v_and_b32 v228, 7, v2
    v_lshlrev_b32 v228, 4, v228
    v_xor_b32 v228, v228, v229
    v_mul_u32_u24 v64, 1024, v64
    v_add_u32 v228, v228, v64
    v_xor_b32 v229, 32, v228
    v_add_u32 v229, 7168, v229
    v_add_u32 v230, 14336, v228
    v_add_u32 v231, 14336, v229
    v_lshrrev_b32 v64, 5, v2
    v_bfe_u32 v65, v2, 2, 2
    v_lshl_add_u32 v246, v64, 2, v65
    v_lshlrev_b32 v246, 7, v246
    v_and_b32 v65, 2, v65
    v_bfe_u32 v64, v2, 4, 1
    v_xor_b32 v65, v65, v64
    v_lshl_add_u32 v246, v65, 5, v246
    v_and_b32 v64, 3, v2
    v_lshl_add_u32 v246, v64, 3, v246
    s_lshl_b32 s98, s3, 5
    v_xor_b32 v246, s98, v246
    v_xor_b32 v247, 32, v246
    v_xor_b32 v248, 64, v246
    v_xor_b32 v249, 96, v246
    s_mul_i32 s90, s3, 458752
    s_lshl_b32 s98, s93, 7
    s_add_u32 s90, s90, s98
    s_lshr_b32 s65, s3, 1
    s_lshl_b32 s95, s2, 1
    s_add_u32 s95, s95, s65
    s_mul_i32 s96, s65, 2080
    s_add_u32 s96, s96, 153216
    s_mul_i32 s67, s3, 4224
    s_add_u32 s67, s67, 131072
    s_and_b32 s65, s3, 1
    s_lshl_b32 s68, s65, 2
    s_sub_u32 s68, 4, s68
    v_add_u32 v62, s68, v58
    v_and_b32 v64, 7, v3
    v_lshlrev_b32 v65, 2, v4
    v_xor_b32 v64, v64, v65
    v_lshlrev_b32 v57, 7, v3
    v_lshl_add_u32 v57, v64, 4, v57
    s_lshl_b32 s68, s3, 15
    s_add_u32 s68, s68, 24576
    v_add_u32 v57, s68, v57
    v_lshrrev_b32 v64, 3, v2
    v_and_b32 v65, 7, v2
    v_xor_b32 v66, v65, v64
    v_lshlrev_b32 v9, 7, v64
    v_lshl_add_u32 v9, v66, 4, v9
    v_add_u32 v9, s68, v9
    v_lshlrev_b32 v65, 4, v65
    v_add_u32 v66, s55, v64
    v_xor_b32 v67, s54, v66
    v_and_b32 v67, 127, v67
    v_lshl_add_u32 v66, v66, 7, v67
    v_lshl_add_u32 v168, v66, 7, v65
    v_add_u32 v66, s55, v64
    v_add_u32 v66, 8, v66
    v_xor_b32 v67, s54, v66
    v_and_b32 v67, 127, v67
    v_lshl_add_u32 v66, v66, 7, v67
    v_lshl_add_u32 v169, v66, 7, v65
    v_add_u32 v66, s55, v64
    v_add_u32 v66, 16, v66
    v_xor_b32 v67, s54, v66
    v_and_b32 v67, 127, v67
    v_lshl_add_u32 v66, v66, 7, v67
    v_lshl_add_u32 v170, v66, 7, v65
    v_add_u32 v66, s55, v64
    v_add_u32 v66, 24, v66
    v_xor_b32 v67, s54, v66
    v_and_b32 v67, 127, v67
    v_lshl_add_u32 v66, v66, 7, v67
    v_lshl_add_u32 v171, v66, 7, v65
    v_xor_b32 v174, 16, v57
    v_xor_b32 v175, 32, v57
    v_xor_b32 v176, 48, v57
    v_lshrrev_b32 v64, 4, v2
    v_bfe_u32 v65, v2, 2, 2
    v_lshl_add_u32 v172, v64, 3, v65
    v_lshlrev_b32 v172, 7, v172
    v_and_b32 v65, 2, v65
    v_and_b32 v64, 1, v64
    v_or_b32 v65, v65, v64
    v_lshl_add_u32 v172, v65, 5, v172
    v_and_b32 v64, 3, v2
    v_lshl_add_u32 v172, v64, 3, v172
    s_lshl_b32 s70, s3, 5
    v_xor_b32 v172, s70, v172
    v_add_u32 v172, 98304, v172
    v_lshrrev_b32 v173, 4, v2
    v_lshlrev_b32 v173, 4, v173
    v_add_u32 v173, 114688, v173
    s_mul_i32 s70, s63, 12288
    s_lshl_b32 s71, s64, 8
    s_add_u32 s70, s70, s71
    s_lshl_b32 s71, s3, 6
    s_add_u32 s70, s70, s71
    s_add_u32 s70, s70, 16842752
    s_lshl_b32 s69, s2, 6
    s_add_u32 s69, s69, 16777216
    s_lshl_b32 s71, s3, 3
    s_add_u32 s71, s71, 114944
    v_mov_b32 v177, s71
    v_add_u32 v59, 114688, v59
    s_waitcnt vmcnt(41)
    v_dot2_f32_bf16 v152, v48, s101, 0
    v_dot2_f32_bf16 v153, v48, v48, 0
    s_waitcnt vmcnt(40)
    v_dot2_f32_bf16 v154, v52, s101, 0
    v_dot2_f32_bf16 v155, v52, v52, 0
    v_dot2_f32_bf16 v152, v49, s101, v152
    v_dot2_f32_bf16 v153, v49, v49, v153
    v_dot2_f32_bf16 v154, v53, s101, v154
    v_dot2_f32_bf16 v155, v53, v53, v155
    v_dot2_f32_bf16 v152, v50, s101, v152
    v_dot2_f32_bf16 v153, v50, v50, v153
    v_dot2_f32_bf16 v154, v54, s101, v154
    v_dot2_f32_bf16 v155, v54, v54, v155
    v_dot2_f32_bf16 v152, v51, s101, v152
    v_dot2_f32_bf16 v153, v51, v51, v153
    v_dot2_f32_bf16 v154, v55, s101, v154
    v_dot2_f32_bf16 v155, v55, v55, v155
    s_waitcnt vmcnt(39)
    v_lshlrev_b32 v164, 16, v56
    v_mul_f32 v165, 0xbfb8aa3b, v164
    v_exp_f32 v165, v165
    v_add_f32_dpp v152, v152, v152 row_shr:1 row_mask:0xf bank_mask:0xf bound_ctrl:0
    v_add_f32_dpp v153, v153, v153 row_shr:1 row_mask:0xf bank_mask:0xf bound_ctrl:0
    v_add_f32_dpp v154, v154, v154 row_shr:1 row_mask:0xf bank_mask:0xf bound_ctrl:0
    v_add_f32_dpp v155, v155, v155 row_shr:1 row_mask:0xf bank_mask:0xf bound_ctrl:0
    v_add_f32 v165, 1.0, v165
    v_add_f32_dpp v152, v152, v152 row_shr:2 row_mask:0xf bank_mask:0xf bound_ctrl:0
    v_add_f32_dpp v153, v153, v153 row_shr:2 row_mask:0xf bank_mask:0xf bound_ctrl:0
    v_add_f32_dpp v154, v154, v154 row_shr:2 row_mask:0xf bank_mask:0xf bound_ctrl:0
    v_add_f32_dpp v155, v155, v155 row_shr:2 row_mask:0xf bank_mask:0xf bound_ctrl:0
    v_rcp_f32 v165, v165
    v_add_f32_dpp v152, v152, v152 row_shr:4 row_mask:0xf bank_mask:0xf bound_ctrl:0
    v_add_f32_dpp v153, v153, v153 row_shr:4 row_mask:0xf bank_mask:0xf bound_ctrl:0
    v_add_f32_dpp v154, v154, v154 row_shr:4 row_mask:0xf bank_mask:0xf bound_ctrl:0
    v_add_f32_dpp v155, v155, v155 row_shr:4 row_mask:0xf bank_mask:0xf bound_ctrl:0
    v_mul_f32 v165, v164, v165
    v_add_f32_dpp v152, v152, v152 row_shr:8 row_mask:0xf bank_mask:0xf bound_ctrl:0
    v_add_f32_dpp v153, v153, v153 row_shr:8 row_mask:0xf bank_mask:0xf bound_ctrl:0
    v_add_f32_dpp v154, v154, v154 row_shr:8 row_mask:0xf bank_mask:0xf bound_ctrl:0
    v_add_f32_dpp v155, v155, v155 row_shr:8 row_mask:0xf bank_mask:0xf bound_ctrl:0
    v_cvt_pk_bf16_f32 v165, v165, v165
    ds_write_b16 v59, v165
    v_add_f32_dpp v152, v152, v152 row_bcast:15 row_mask:0xa bank_mask:0xf
    v_add_f32_dpp v153, v153, v153 row_bcast:15 row_mask:0xa bank_mask:0xf
    v_add_f32_dpp v154, v154, v154 row_bcast:15 row_mask:0xa bank_mask:0xf
    v_add_f32_dpp v155, v155, v155 row_bcast:15 row_mask:0xa bank_mask:0xf
    v_add_f32_dpp v152, v152, v152 row_bcast:31 row_mask:0xc bank_mask:0xf
    v_add_f32_dpp v153, v153, v153 row_bcast:31 row_mask:0xc bank_mask:0xf
    v_add_f32_dpp v154, v154, v154 row_bcast:31 row_mask:0xc bank_mask:0xf
    v_add_f32_dpp v155, v155, v155 row_bcast:31 row_mask:0xc bank_mask:0xf
    v_mul_f32 v152, 0x3b000000, v152
    v_mul_f32 v153, 0x3b000000, v153
    v_mul_f32 v154, 0x3b000000, v154
    v_mul_f32 v155, 0x3b000000, v155
    v_fma_f32 v153, -v152, v152, v153
    v_fma_f32 v155, -v154, v154, v155
    v_max_f32 v153, 0, v153
    v_max_f32 v155, 0, v155
    v_cvt_pk_bf16_f32 v160, v152, v153
    v_cvt_pk_bf16_f32 v161, v154, v155
    v_lshlrev_b32 v152, 16, v160
    v_and_b32 v153, 0xffff0000, v160
    v_lshlrev_b32 v154, 16, v161
    v_and_b32 v155, 0xffff0000, v161
    v_add_f32 v153, 0x3727c5ac, v153
    v_add_f32 v155, 0x3727c5ac, v155
    v_cvt_pk_bf16_f32 v153, v153, v153
    v_cvt_pk_bf16_f32 v155, v155, v155
    v_lshlrev_b32 v153, 16, v153
    v_lshlrev_b32 v155, 16, v155
    v_sqrt_f32 v153, v153
    v_sqrt_f32 v155, v155
    v_cvt_pk_bf16_f32 v153, v153, v153
    v_cvt_pk_bf16_f32 v155, v155, v155
    v_lshlrev_b32 v153, 16, v153
    v_lshlrev_b32 v155, 16, v155
    v_rcp_f32 v156, v153
    v_rcp_f32 v157, v155
    v_mul_f32 v158, -v152, v156
    v_mul_f32 v159, -v154, v157
    s_lshl_b64 exec, 1, 63
    ds_write_b64 v177, v[156:157]
    ds_write_b64 v177, v[158:159] offset:32
    s_mov_b64 exec, -1
    s_waitcnt vmcnt(37)
    v_perm_b32 v68, v11, v10, s99
    v_perm_b32 v69, v11, v10, s100
    s_waitcnt vmcnt(35)
    v_perm_b32 v70, v13, v12, s99
    v_perm_b32 v71, v13, v12, s100
    s_waitcnt vmcnt(33)
    v_perm_b32 v72, v15, v14, s99
    v_perm_b32 v73, v15, v14, s100
    s_waitcnt vmcnt(31)
    v_perm_b32 v74, v17, v16, s99
    v_perm_b32 v75, v17, v16, s100
    s_waitcnt vmcnt(29)
    v_perm_b32 v76, v19, v18, s99
    v_perm_b32 v77, v19, v18, s100
    s_waitcnt vmcnt(27)
    v_perm_b32 v78, v21, v20, s99
    v_perm_b32 v79, v21, v20, s100
    s_waitcnt vmcnt(25)
    v_perm_b32 v80, v23, v22, s99
    v_perm_b32 v81, v23, v22, s100
    s_waitcnt vmcnt(23)
    v_perm_b32 v82, v25, v24, s99
    v_perm_b32 v83, v25, v24, s100
    s_waitcnt vmcnt(21)
    v_perm_b32 v84, v27, v26, s99
    v_perm_b32 v85, v27, v26, s100
    s_waitcnt vmcnt(20)
    v_alignbit_b32 v64, v45, v45, 16
    v_alignbit_b32 v65, v44, v44, 16
    v_alignbit_b32 v66, v47, v47, 16
    v_alignbit_b32 v67, v46, v46, 16
    v_dot2_f32_bf16 v86, v68, v64, 0
    v_dot2_f32_bf16 v87, v69, v66, 0
    v_dot2_f32_bf16 v88, v70, v64, 0
    v_dot2_f32_bf16 v89, v71, v66, 0
    v_dot2_f32_bf16 v90, v72, v64, 0
    v_dot2_f32_bf16 v91, v73, v66, 0
    v_dot2_f32_bf16 v92, v74, v64, 0
    v_dot2_f32_bf16 v93, v75, v66, 0
    v_dot2_f32_bf16 v94, v76, v64, 0
    v_dot2_f32_bf16 v95, v77, v66, 0
    v_dot2_f32_bf16 v96, v78, v64, 0
    v_dot2_f32_bf16 v97, v79, v66, 0
    v_dot2_f32_bf16 v98, v80, v64, 0
    v_dot2_f32_bf16 v99, v81, v66, 0
    v_dot2_f32_bf16 v100, v82, v64, 0
    v_dot2_f32_bf16 v101, v83, v66, 0
    v_dot2_f32_bf16 v86, v70, v65, v86
    v_dot2_f32_bf16 v87, v71, v67, v87
    v_dot2_f32_bf16 v88, v72, v65, v88
    v_dot2_f32_bf16 v89, v73, v67, v89
    v_dot2_f32_bf16 v90, v74, v65, v90
    v_dot2_f32_bf16 v91, v75, v67, v91
    v_dot2_f32_bf16 v92, v76, v65, v92
    v_dot2_f32_bf16 v93, v77, v67, v93
    v_dot2_f32_bf16 v94, v78, v65, v94
    v_dot2_f32_bf16 v95, v79, v67, v95
    v_dot2_f32_bf16 v96, v80, v65, v96
    v_dot2_f32_bf16 v97, v81, v67, v97
    v_dot2_f32_bf16 v98, v82, v65, v98
    v_dot2_f32_bf16 v99, v83, v67, v99
    v_dot2_f32_bf16 v100, v84, v65, v100
    v_dot2_f32_bf16 v101, v85, v67, v101
    s_waitcnt vmcnt(19)
    v_lshlrev_b32 v102, 16, v28
    v_and_b32 v103, 0xffff0000, v28
    s_waitcnt vmcnt(18)
    v_lshlrev_b32 v104, 16, v29
    v_and_b32 v105, 0xffff0000, v29
    s_waitcnt vmcnt(17)
    v_lshlrev_b32 v106, 16, v30
    v_and_b32 v107, 0xffff0000, v30
    s_waitcnt vmcnt(16)
    v_lshlrev_b32 v108, 16, v31
    v_and_b32 v109, 0xffff0000, v31
    s_waitcnt vmcnt(15)
    v_lshlrev_b32 v110, 16, v32
    v_and_b32 v111, 0xffff0000, v32
    s_waitcnt vmcnt(14)
    v_lshlrev_b32 v112, 16, v33
    v_and_b32 v113, 0xffff0000, v33
    s_waitcnt vmcnt(13)
    v_lshlrev_b32 v114, 16, v34
    v_and_b32 v115, 0xffff0000, v34
    s_waitcnt vmcnt(12)
    v_lshlrev_b32 v116, 16, v35
    v_and_b32 v117, 0xffff0000, v35
    v_pk_mul_f32 v[86:87], v[86:87], v[102:103]
    v_pk_mul_f32 v[88:89], v[88:89], v[104:105]
    v_pk_mul_f32 v[90:91], v[90:91], v[106:107]
    v_pk_mul_f32 v[92:93], v[92:93], v[108:109]
    v_pk_mul_f32 v[94:95], v[94:95], v[110:111]
    v_pk_mul_f32 v[96:97], v[96:97], v[112:113]
    v_pk_mul_f32 v[98:99], v[98:99], v[114:115]
    v_pk_mul_f32 v[100:101], v[100:101], v[116:117]
    v_cvt_pk_bf16_f32 v120, v100, v98
    v_cvt_pk_bf16_f32 v121, v96, v94
    v_cvt_pk_bf16_f32 v122, v92, v90
    v_cvt_pk_bf16_f32 v123, v88, v86
    ds_write_b128 v57, v[120:123]
    v_cvt_pk_bf16_f32 v124, v101, v99
    v_cvt_pk_bf16_f32 v125, v97, v95
    v_cvt_pk_bf16_f32 v126, v93, v91
    v_cvt_pk_bf16_f32 v127, v89, v87
    ds_write_b128 v174, v[124:127]
    s_waitcnt vmcnt(4)
    v_perm_b32 v128, v42, v43, s99
    v_perm_b32 v129, v40, v41, s99
    v_perm_b32 v130, v38, v39, s99
    v_perm_b32 v131, v36, v37, s99
    ds_write_b128 v175, v[128:131]
    v_perm_b32 v132, v42, v43, s100
    v_perm_b32 v133, v40, v41, s100
    v_perm_b32 v134, v38, v39, s100
    v_perm_b32 v135, v36, v37, s100
    ds_write_b128 v176, v[132:135]
    s_waitcnt lgkmcnt(0)
    ds_read_b128 v[136:139], v9 offset:0
    ds_read_b128 v[140:143], v9 offset:1024
    ds_read_b128 v[144:147], v9 offset:2048
    ds_read_b128 v[148:151], v9 offset:3072
    s_waitcnt lgkmcnt(3)
    buffer_store_dwordx4 v[136:139], v168, s[36:39], 0 offen sc1
    s_waitcnt lgkmcnt(2)
    buffer_store_dwordx4 v[140:143], v169, s[36:39], 0 offen sc1
    s_waitcnt lgkmcnt(1)
    buffer_store_dwordx4 v[144:147], v170, s[36:39], 0 offen sc1
    s_waitcnt lgkmcnt(0)
    buffer_store_dwordx4 v[148:151], v171, s[36:39], 0 offen sc1
    s_waitcnt vmcnt(4) lgkmcnt(0)
    s_barrier
    v_add_u32 v177, 114944, v58
    ds_read_b128 v[152:155], v177
    ds_read_b128 v[72:75], v173 offset:0
    ds_read_b64_tr_b16 v[88:89], v172 offset:0
    ds_read_b64_tr_b16 v[90:91], v172 offset:512
    ds_read_b128 v[76:79], v173 offset:64
    ds_read_b64_tr_b16 v[92:93], v172 offset:4096
    ds_read_b64_tr_b16 v[94:95], v172 offset:4608
    ds_read_b128 v[80:83], v173 offset:128
    ds_read_b64_tr_b16 v[96:97], v172 offset:8192
    ds_read_b64_tr_b16 v[98:99], v172 offset:8704
    ds_read_b128 v[84:87], v173 offset:192
    ds_read_b64_tr_b16 v[100:101], v172 offset:12288
    ds_read_b64_tr_b16 v[102:103], v172 offset:12800
    s_cmp_eq_u32 s3, 0
    s_cbranch_scc0 L_nost1
    s_mov_b64 exec, 0xf
    s_waitcnt lgkmcnt(12)
    buffer_store_dwordx4 v[152:155], v58, s[36:39], s69 offen sc1
    s_mov_b64 exec, -1
L_nost1:
    s_waitcnt lgkmcnt(9)
    v_mfma_f32_16x16x32_bf16 v[104:107], v[72:75], v[88:91], 0
    s_waitcnt lgkmcnt(6)
    v_mfma_f32_16x16x32_bf16 v[104:107], v[76:79], v[92:95], v[104:107]
    s_waitcnt lgkmcnt(3)
    v_mfma_f32_16x16x32_bf16 v[104:107], v[80:83], v[96:99], v[104:107]
    s_waitcnt lgkmcnt(0)
    v_mfma_f32_16x16x32_bf16 v[104:107], v[84:87], v[100:103], v[104:107]
    v_lshlrev_b32 v64, 2, v2
    s_cmp_ge_u32 s2, 192
    s_cbranch_scc1 L_nogemv
    s_mov_b64 exec, 0xffff
    s_nop 3
    buffer_store_dword v104, v64, s[36:39], s70 offen sc1
    s_mov_b64 exec, -1
L_nogemv:
    s_add_u32 s84, s84, 1
    s_cmp_eq_u32 s3, 3
    s_cbranch_scc1 L_s3a_2
    s_lshl_b32 s72, s95, 12
    s_add_u32 m0, s67, 32
    v_mov_b32 v63, 0
    buffer_load_dword v63, v63, s[16:19], s72 offen
    buffer_load_dwordx4 v62, s[16:19], s72 offen offset:0 lds
    buffer_load_dwordx4 v62, s[16:19], s72 offen offset:1024 lds
    buffer_load_dwordx4 v62, s[16:19], s72 offen offset:2048 lds
    buffer_load_dwordx4 v62, s[16:19], s72 offen offset:3072 lds
    s_waitcnt vmcnt(5)
    s_branch L_s3b_2
L_s3a_2:
    s_waitcnt vmcnt(0)
L_s3b_2:
    s_barrier
    s_cmp_eq_u32 s3, 3
    s_cbranch_scc1 L_s3a_3
    s_cmp_eq_u32 s3, 2
    s_cbranch_scc0 L_nokc3
    s_mov_b32 m0, 143776
    s_nop 0
    buffer_load_dwordx4 v58, s[16:19], s72 offen offset:0 lds
    buffer_load_dwordx4 v58, s[16:19], s72 offen offset:1024 lds
    buffer_load_dwordx4 v58, s[16:19], s72 offen offset:2048 lds
    buffer_load_dwordx4 v58, s[16:19], s72 offen offset:3072 lds
L_nokc3:
    s_add_u32 s98, s94, 0
    s_lshl_b32 m0, 0, 13
    s_bitcmp1_b32 s98, 2
    s_cselect_b64 vcc, -1, 0
    s_add_u32 m0, m0, s89
    s_and_b32 s98, s98, 3
    v_cndmask_b32 v245, v236, v237, vcc
    v_add_u32 v64, v245, v238
    v_add_u32 v65, v245, v239
    v_add_u32 v66, v245, v240
    v_add_u32 v67, v245, v241
    s_mul_i32 s86, s98, 229376
    s_lshl_b32 s98, s88, 8
    s_add_u32 s86, s86, s98
    s_lshl_b32 s98, s3, 6
    s_add_u32 s86, s86, s98
    buffer_load_dwordx4 v64, s[20:23], s86 offen offset:0 lds
    s_waitcnt vmcnt(7)
    buffer_load_dwordx4 v65, s[20:23], s86 offen offset:1024 lds
    s_waitcnt vmcnt(7)
    buffer_load_dwordx4 v66, s[20:23], s86 offen offset:2048 lds
    s_waitcnt vmcnt(7)
    buffer_load_dwordx4 v67, s[20:23], s86 offen offset:3072 lds
    s_waitcnt vmcnt(7)
    s_add_u32 m0, m0, 4096
    s_add_u32 s86, s86, 114688
    buffer_load_dwordx4 v64, s[20:23], s86 offen offset:0 lds
    s_waitcnt vmcnt(7)
    buffer_load_dwordx4 v65, s[20:23], s86 offen offset:1024 lds
    s_waitcnt vmcnt(7)
    buffer_load_dwordx4 v66, s[20:23], s86 offen offset:2048 lds
    s_waitcnt vmcnt(7)
    buffer_load_dwordx4 v67, s[20:23], s86 offen offset:3072 lds
    s_waitcnt vmcnt(7)
    s_add_u32 s98, s94, 1
    s_lshl_b32 m0, 1, 13
    s_bitcmp1_b32 s98, 2
    s_cselect_b64 vcc, -1, 0
    s_add_u32 m0, m0, s89
    s_and_b32 s98, s98, 3
    v_cndmask_b32 v245, v236, v237, vcc
    v_add_u32 v64, v245, v238
    v_add_u32 v65, v245, v239
    v_add_u32 v66, v245, v240
    v_add_u32 v67, v245, v241
    s_mul_i32 s86, s98, 229376
    s_lshl_b32 s98, s88, 8
    s_add_u32 s86, s86, s98
    s_lshl_b32 s98, s3, 6
    s_add_u32 s86, s86, s98
    buffer_load_dwordx4 v64, s[20:23], s86 offen offset:0 lds
    s_waitcnt vmcnt(7)
    buffer_load_dwordx4 v65, s[20:23], s86 offen offset:1024 lds
    s_waitcnt vmcnt(7)
    buffer_load_dwordx4 v66, s[20:23], s86 offen offset:2048 lds
    s_waitcnt vmcnt(7)
    buffer_load_dwordx4 v67, s[20:23], s86 offen offset:3072 lds
    s_waitcnt vmcnt(7)
    s_add_u32 m0, m0, 4096
    s_add_u32 s86, s86, 114688
    buffer_load_dwordx4 v64, s[20:23], s86 offen offset:0 lds
    s_waitcnt vmcnt(7)
    buffer_load_dwordx4 v65, s[20:23], s86 offen offset:1024 lds
    s_waitcnt vmcnt(7)
    buffer_load_dwordx4 v66, s[20:23], s86 offen offset:2048 lds
    s_waitcnt vmcnt(7)
    buffer_load_dwordx4 v67, s[20:23], s86 offen offset:3072 lds
    s_waitcnt vmcnt(7)
    s_add_u32 s98, s94, 2
    s_lshl_b32 m0, 2, 13
    s_bitcmp1_b32 s98, 2
    s_cselect_b64 vcc, -1, 0
    s_add_u32 m0, m0, s89
    s_and_b32 s98, s98, 3
    v_cndmask_b32 v245, v236, v237, vcc
    v_add_u32 v64, v245, v238
    v_add_u32 v65, v245, v239
    v_add_u32 v66, v245, v240
    v_add_u32 v67, v245, v241
    s_mul_i32 s86, s98, 229376
    s_lshl_b32 s98, s88, 8
    s_add_u32 s86, s86, s98
    s_lshl_b32 s98, s3, 6
    s_add_u32 s86, s86, s98
    buffer_load_dwordx4 v64, s[20:23], s86 offen offset:0 lds
    s_waitcnt vmcnt(7)
    buffer_load_dwordx4 v65, s[20:23], s86 offen offset:1024 lds
    s_waitcnt vmcnt(7)
    buffer_load_dwordx4 v66, s[20:23], s86 offen offset:2048 lds
    s_waitcnt vmcnt(7)
    buffer_load_dwordx4 v67, s[20:23], s86 offen offset:3072 lds
    s_waitcnt vmcnt(7)
    s_add_u32 m0, m0, 4096
    s_add_u32 s86, s86, 114688
    buffer_load_dwordx4 v64, s[20:23], s86 offen offset:0 lds
    s_waitcnt vmcnt(7)
    buffer_load_dwordx4 v65, s[20:23], s86 offen offset:1024 lds
    s_waitcnt vmcnt(7)
    buffer_load_dwordx4 v66, s[20:23], s86 offen offset:2048 lds
    s_waitcnt vmcnt(7)
    buffer_load_dwordx4 v67, s[20:23], s86 offen offset:3072 lds
    s_waitcnt vmcnt(7)
    s_branch L_s3b_3
L_s3a_3:
    s_lshl_b32 s98, s2, 7
    s_add_u32 s98, s98, 17891328
    s_mov_b64 exec, 1
    v_mov_b32 v252, 0
    v_mov_b32 v254, s84
    v_mov_b32 v255, s85
    buffer_store_dwordx2 v[254:255], v252, s[36:39], s98 offen sc1
    s_mov_b64 exec, -1
L_s3b_3:
    s_mul_i32 s65, s65, 64
    s_add_u32 s65, s65, 7
    v_lshlrev_b32 v62, 2, v2
    v_add_u32 v62, s67, v62
    v_lshrrev_b32 v3, 3, v2
    s_and_b32 s60, s2, 7
    v_xor_b32 v3, s60, v3
    v_lshlrev_b32 v3, 7, v3
    v_lshrrev_b32 v4, 4, v2
    v_and_b32 v7, 7, v2
    v_xor_b32 v7, v7, v4
    v_lshl_add_u32 v3, v7, 4, v3
    v_xor_b32 v7, 64, v3
    s_lshl_b32 s60, s2, 14
    s_bfe_u32 s62, s2, 0x40003
    s_lshl_b32 s62, s62, 10
    s_lshl_b32 s61, s3, 12
    v_and_b32 v21, 3, v2
    v_mul_u32_u24 v21, 12288, v21
    v_bfe_u32 v22, v2, 2, 2
    v_lshl_add_u32 v21, v22, 11, v21
    v_add_u32 v23, 2048, v21
    v_cmp_eq_u32 vcc, 3, v22
    s_lshl_b32 s63, s95, 2
    s_add_u32 s63, s63, 16842752
    v_cndmask_b32 v21, v21, v23, vcc
    s_lshl_b32 s64, s95, 1
    v_and_b32 v6, 15, v2
    v_lshrrev_b32 v18, 1, v4
    v_lshlrev_b32 v18, 2, v18
    v_and_b32 v23, 1, v4
    v_or_b32 v18, v18, v23
    v_lshrrev_b32 v23, 1, v6
    v_xor_b32 v18, v18, v23
    v_lshlrev_b32 v23, 7, v6
    v_lshl_add_u32 v23, v18, 4, v23
    v_add_u32 v23, 116736, v23
    v_xor_b32 v216, 32, v23
    v_lshlrev_b32 v5, 4, v2
    v_lshlrev_b32 v18, 4, v4
    v_xor_b32 v226, v5, v18
    v_xor_b32 v227, 64, v226
    v_lshlrev_b32 v18, 3, v0
    v_add_u32 v18, 98304, v18
    v_mov_b32 v72, 0
    v_mov_b32 v73, 0
    ds_write_b64 v18, v[72:73]
    v_mov_b32 v18, s96
    ds_write_b32 v18, v72
    s_lshr_b32 s66, s3, 1
    v_sub_u32 v18, v6, v4
    v_add_u32 v18, 16, v18
    v_bfe_u32 v19, v18, 1, 3
    v_xor_b32 v19, s66, v19
    v_lshlrev_b32 v18, 7, v18
    v_lshl_add_u32 v18, v19, 4, v18
    v_add_u32 v8, 98304, v18
    v_xor_b32 v9, 64, v8
    v_sub_u32 v18, v6, v4
    v_add_u32 v18, 12, v18
    v_bfe_u32 v19, v18, 1, 3
    v_xor_b32 v19, s66, v19
    v_lshlrev_b32 v18, 7, v18
    v_lshl_add_u32 v18, v19, 4, v18
    v_add_u32 v10, 98304, v18
    v_xor_b32 v11, 64, v10
    v_sub_u32 v18, v6, v4
    v_add_u32 v18, 8, v18
    v_bfe_u32 v19, v18, 1, 3
    v_xor_b32 v19, s66, v19
    v_lshlrev_b32 v18, 7, v18
    v_lshl_add_u32 v18, v19, 4, v18
    v_add_u32 v12, 98304, v18
    v_xor_b32 v13, 64, v12
    v_sub_u32 v18, v6, v4
    v_add_u32 v18, 4, v18
    v_bfe_u32 v19, v18, 1, 3
    v_xor_b32 v19, s66, v19
    v_lshlrev_b32 v18, 7, v18
    v_lshl_add_u32 v18, v19, 4, v18
    v_add_u32 v14, 98304, v18
    v_xor_b32 v15, 64, v14
    v_bfe_u32 v18, v2, 2, 2
    v_and_b32 v19, 1, v18
    v_add_u32 v18, 1, v18
    v_lshrrev_b32 v18, 1, v18
    v_and_b32 v20, 3, v2
    v_add_u32 v18, v18, v20
    v_lshlrev_b32 v18, 3, v18
    v_lshl_add_u32 v18, v4, 5, v18
    v_mul_u32_u24 v19, 4224, v19
    s_mul_i32 s67, s66, 8448
    s_add_u32 s67, s67, 131072
    v_add3_u32 v16, v18, v19, s67
    v_bfe_u32 v19, v6, 1, 3
    v_xor_b32 v19, s66, v19
    v_lshlrev_b32 v18, 7, v6
    v_lshl_add_u32 v18, v19, 4, v18
    v_sub_u32 v19, 3, v4
    v_lshl_add_u32 v18, v19, 2, v18
    v_add_u32 v17, 100352, v18
    v_xor_b32 v18, 64, v17
    v_xor_b32 v19, 32, v17
    v_xor_b32 v20, 96, v17
    v_lshl_add_u32 v218, v6, 2, v4
    v_lshl_add_u32 v218, v218, 2, s96
    s_add_u32 s68, s61, 131072
    v_bfe_u32 v24, v6, 2, 1
    v_lshlrev_b32 v24, 1, v24
    v_xor_b32 v24, v24, v4
    v_lshlrev_b32 v219, 5, v6
    v_lshl_add_u32 v219, v24, 3, v219
    v_add_u32 v219, s68, v219
    v_bfe_u32 v24, v2, 3, 1
    v_lshlrev_b32 v24, 4, v24
    v_xor_b32 v220, v24, v5
    v_add_u32 v220, s68, v220
    s_bitcmp1_b32 s3, 0
    s_cselect_b32 s68, 6, 7
    s_cselect_b32 s69, 5, 4
    v_mov_b32 v24, s68
    v_mov_b32 v25, s69
    s_mov_b32 vcc_lo, 0
    s_mov_b32 vcc_hi, -1
    v_cndmask_b32 v24, v24, v25, vcc
    v_and_b32 v25, 0x1ff, v5
    v_lshl_add_u32 v221, v24, 9, v25
    s_cselect_b32 s68, 2, 3
    s_cselect_b32 s69, 1, 0
    v_mov_b32 v24, s68
    v_mov_b32 v25, s69
    s_mov_b32 vcc_lo, 0
    s_mov_b32 vcc_hi, -1
    v_cndmask_b32 v24, v24, v25, vcc
    v_and_b32 v25, 0x1ff, v5
    v_lshl_add_u32 v222, v24, 9, v25
    s_lshl_b32 s96, s95, 12
    v_mov_b32 v22, 0
    buffer_load_ushort v22, v22, s[48:51], s64 offen
    s_cmp_eq_u32 s3, 3
    s_cbranch_scc1 L_s3a_4
    s_waitcnt vmcnt(17)
    ds_read_b64_tr_b16 a[0:1], v242 offset:0
    ds_read_b64_tr_b16 a[2:3], v242 offset:512
    ds_read_b64_tr_b16 a[64:65], v243 offset:0
    ds_read_b64_tr_b16 a[66:67], v243 offset:512
    ds_read_b64_tr_b16 a[4:5], v242 offset:2048
    ds_read_b64_tr_b16 a[6:7], v242 offset:2560
    ds_read_b64_tr_b16 a[68:69], v243 offset:2048
    ds_read_b64_tr_b16 a[70:71], v243 offset:2560
    ds_read_b64_tr_b16 a[8:9], v242 offset:4096
    ds_read_b64_tr_b16 a[10:11], v242 offset:4608
    ds_read_b64_tr_b16 a[72:73], v243 offset:4096
    ds_read_b64_tr_b16 a[74:75], v243 offset:4608
    ds_read_b64_tr_b16 a[12:13], v242 offset:6144
    ds_read_b64_tr_b16 a[14:15], v242 offset:6656
    ds_read_b64_tr_b16 a[76:77], v243 offset:6144
    ds_read_b64_tr_b16 a[78:79], v243 offset:6656
    s_waitcnt vmcnt(9)
    ds_read_b64_tr_b16 a[16:17], v242 offset:8192
    ds_read_b64_tr_b16 a[18:19], v242 offset:8704
    ds_read_b64_tr_b16 a[80:81], v243 offset:8192
    ds_read_b64_tr_b16 a[82:83], v243 offset:8704
    ds_read_b64_tr_b16 a[20:21], v242 offset:10240
    ds_read_b64_tr_b16 a[22:23], v242 offset:10752
    ds_read_b64_tr_b16 a[84:85], v243 offset:10240
    ds_read_b64_tr_b16 a[86:87], v243 offset:10752
    ds_read_b64_tr_b16 a[24:25], v242 offset:12288
    ds_read_b64_tr_b16 a[26:27], v242 offset:12800
    ds_read_b64_tr_b16 a[88:89], v243 offset:12288
    ds_read_b64_tr_b16 a[90:91], v243 offset:12800
    ds_read_b64_tr_b16 a[28:29], v242 offset:14336
    ds_read_b64_tr_b16 a[30:31], v242 offset:14848
    ds_read_b64_tr_b16 a[92:93], v243 offset:14336
    ds_read_b64_tr_b16 a[94:95], v243 offset:14848
    s_waitcnt vmcnt(1)
    ds_read_b64_tr_b16 a[32:33], v242 offset:16384
    ds_read_b64_tr_b16 a[34:35], v242 offset:16896
    ds_read_b64_tr_b16 a[96:97], v243 offset:16384
    ds_read_b64_tr_b16 a[98:99], v243 offset:16896
    ds_read_b64_tr_b16 a[36:37], v242 offset:18432
    ds_read_b64_tr_b16 a[38:39], v242 offset:18944
    ds_read_b64_tr_b16 a[100:101], v243 offset:18432
    ds_read_b64_tr_b16 a[102:103], v243 offset:18944
    ds_read_b64_tr_b16 a[40:41], v242 offset:20480
    ds_read_b64_tr_b16 a[42:43], v242 offset:20992
    ds_read_b64_tr_b16 a[104:105], v243 offset:20480
    ds_read_b64_tr_b16 a[106:107], v243 offset:20992
    ds_read_b64_tr_b16 a[44:45], v242 offset:22528
    ds_read_b64_tr_b16 a[46:47], v242 offset:23040
    ds_read_b64_tr_b16 a[108:109], v243 offset:22528
    ds_read_b64_tr_b16 a[110:111], v243 offset:23040
    s_branch L_s3b_4
L_s3a_4:
    v_lshlrev_b32 v40, 7, v2
    s_mov_b64 s[76:77], -1
    s_mov_b64 s[78:79], -1
    v_add_u32 v41, 8192, v40
    s_mov_b64 s[80:81], -1
    v_add_u32 v42, 16384, v40
    s_mov_b64 s[82:83], -1
    v_add_u32 v43, 24576, v40
    s_mov_b32 s98, 17891328
    s_mov_b32 s97, 0x40000
    s_sleep 28
L_lf6:
    s_or_b64 exec, s[76:77], 1
    buffer_load_dwordx2 v[24:25], v40, s[36:39], s98 offen sc1
    s_or_b64 exec, s[78:79], 1
    buffer_load_dwordx2 v[26:27], v41, s[36:39], s98 offen sc1
    s_or_b64 exec, s[80:81], 1
    buffer_load_dwordx2 v[28:29], v42, s[36:39], s98 offen sc1
    s_or_b64 exec, s[82:83], 1
    buffer_load_dwordx2 v[30:31], v43, s[36:39], s98 offen sc1
    s_waitcnt vmcnt(0)
    s_mov_b64 exec, s[76:77]
    v_cmp_ne_u64 s[76:77], s[84:85], v[24:25]
    s_mov_b64 exec, s[78:79]
    v_cmp_ne_u64 s[78:79], s[84:85], v[26:27]
    s_mov_b64 exec, s[80:81]
    v_cmp_ne_u64 s[80:81], s[84:85], v[28:29]
    s_mov_b64 exec, s[82:83]
    v_cmp_ne_u64 s[82:83], s[84:85], v[30:31]
    s_or_b64 vcc, s[76:77], s[78:79]
    s_or_b64 vcc, vcc, s[80:81]
    s_or_b64 vcc, vcc, s[82:83]
    s_cbranch_scc0 L_lfx6
    s_bcnt1_i32_b64 s86, vcc
    s_cmp_gt_u32 s86, 24
    s_cbranch_scc0 L_lfs6
    s_sleep 24
L_lfs6:
    s_sleep 1
    s_sub_u32 s97, s97, 1
    s_cbranch_scc0 L_lf6
L_lfx6:
    s_mov_b64 exec, -1
    s_mov_b32 m0, 100352
    s_xor_b32 s54, s62, 0
    s_add_u32 s54, s54, s60
    buffer_load_dwordx4 v3, s[36:39], s54 offen sc1 lds
    s_add_u32 m0, m0, 1024
    s_xor_b32 s54, s62, 1024
    s_add_u32 s54, s54, s60
    buffer_load_dwordx4 v7, s[36:39], s54 offen sc1 lds
    s_add_u32 m0, m0, 1024
    s_xor_b32 s54, s62, 2048
    s_add_u32 s54, s54, s60
    buffer_load_dwordx4 v3, s[36:39], s54 offen sc1 lds
    s_add_u32 m0, m0, 1024
    s_xor_b32 s54, s62, 3072
    s_add_u32 s54, s54, s60
    buffer_load_dwordx4 v7, s[36:39], s54 offen sc1 lds
    s_add_u32 m0, m0, 1024
    s_xor_b32 s54, s62, 4096
    s_add_u32 s54, s54, s60
    buffer_load_dwordx4 v3, s[36:39], s54 offen sc1 lds
    s_add_u32 m0, m0, 1024
    s_xor_b32 s54, s62, 5120
    s_add_u32 s54, s54, s60
    buffer_load_dwordx4 v7, s[36:39], s54 offen sc1 lds
    s_add_u32 m0, m0, 1024
    s_xor_b32 s54, s62, 6144
    s_add_u32 s54, s54, s60
    buffer_load_dwordx4 v3, s[36:39], s54 offen sc1 lds
    s_add_u32 m0, m0, 1024
    s_xor_b32 s54, s62, 7168
    s_add_u32 s54, s54, s60
    buffer_load_dwordx4 v7, s[36:39], s54 offen sc1 lds
    s_add_u32 m0, m0, 1024
    s_xor_b32 s54, s62, 8192
    s_add_u32 s54, s54, s60
    buffer_load_dwordx4 v3, s[36:39], s54 offen sc1 lds
    s_add_u32 m0, m0, 1024
    s_xor_b32 s54, s62, 9216
    s_add_u32 s54, s54, s60
    buffer_load_dwordx4 v7, s[36:39], s54 offen sc1 lds
    s_add_u32 m0, m0, 1024
    s_xor_b32 s54, s62, 10240
    s_add_u32 s54, s54, s60
    buffer_load_dwordx4 v3, s[36:39], s54 offen sc1 lds
    s_add_u32 m0, m0, 1024
    s_xor_b32 s54, s62, 11264
    s_add_u32 s54, s54, s60
    buffer_load_dwordx4 v7, s[36:39], s54 offen sc1 lds
    s_add_u32 m0, m0, 1024
    s_xor_b32 s54, s62, 12288
    s_add_u32 s54, s54, s60
    buffer_load_dwordx4 v3, s[36:39], s54 offen sc1 lds
    s_add_u32 m0, m0, 1024
    s_xor_b32 s54, s62, 13312
    s_add_u32 s54, s54, s60
    buffer_load_dwordx4 v7, s[36:39], s54 offen sc1 lds
    s_add_u32 m0, m0, 1024
    s_xor_b32 s54, s62, 14336
    s_add_u32 s54, s54, s60
    buffer_load_dwordx4 v3, s[36:39], s54 offen sc1 lds
    s_add_u32 m0, m0, 1024
    s_xor_b32 s54, s62, 15360
    s_add_u32 s54, s54, s60
    buffer_load_dwordx4 v7, s[36:39], s54 offen sc1 lds
    s_cmp_eq_u32 s2, 0
    s_cbranch_scc0 L_noep
    s_lshl_b32 s98, s2, 7
    s_add_u32 s98, s98, 17826048
    s_mov_b64 exec, 1
    v_mov_b32 v252, 0
    v_mov_b32 v254, s84
    v_mov_b32 v255, s85
    buffer_store_dwordx2 v[254:255], v252, s[36:39], s98 offen sc1
    s_mov_b64 exec, -1
L_noep:
    s_mov_b32 m0, 116736
    s_mov_b32 s54, 16777216
    buffer_load_dwordx4 v226, s[36:39], s54 offen offset:0 sc1 lds
    buffer_load_dwordx4 v227, s[36:39], s54 offen offset:1024 sc1 lds
    buffer_load_dwordx4 v226, s[36:39], s54 offen offset:2048 sc1 lds
    buffer_load_dwordx4 v227, s[36:39], s54 offen offset:3072 sc1 lds
    s_mov_b32 m0, 120832
    s_mov_b32 s54, 16781312
    buffer_load_dwordx4 v226, s[36:39], s54 offen offset:0 sc1 lds
    buffer_load_dwordx4 v227, s[36:39], s54 offen offset:1024 sc1 lds
    buffer_load_dwordx4 v226, s[36:39], s54 offen offset:2048 sc1 lds
    buffer_load_dwordx4 v227, s[36:39], s54 offen offset:3072 sc1 lds
    s_mov_b32 m0, 124928
    s_mov_b32 s54, 16785408
    buffer_load_dwordx4 v226, s[36:39], s54 offen offset:0 sc1 lds
    buffer_load_dwordx4 v227, s[36:39], s54 offen offset:1024 sc1 lds
    buffer_load_dwordx4 v226, s[36:39], s54 offen offset:2048 sc1 lds
    buffer_load_dwordx4 v227, s[36:39], s54 offen offset:3072 sc1 lds
    s_mov_b32 m0, 129024
    s_mov_b32 s54, 16789504
    buffer_load_dwordx4 v226, s[36:39], s54 offen offset:0 sc1 lds
    buffer_load_dwordx4 v227, s[36:39], s54 offen offset:1024 sc1 lds
    s_mov_b32 m0, 155392
    s_mov_b32 s54, 16789504
    buffer_load_dwordx4 v226, s[36:39], s54 offen offset:2048 sc1 lds
    buffer_load_dwordx4 v227, s[36:39], s54 offen offset:3072 sc1 lds
    s_mul_i32 s72, s2, 7168
    v_lshlrev_b32 v254, 7, v2
    s_mov_b32 exec_hi, 0xffffff
    buffer_load_dword v255, v254, s[24:27], s72 offen
    s_mov_b64 exec, -1
    s_waitcnt vmcnt(17)
L_s3b_4:
    v_cmp_eq_u32 vcc, s65, v2
    s_nop 1
    v_cndmask_b32 v63, 0, v63, vcc
    s_mov_b64 exec, 0xff
    ds_write_b32 v62, v63
    s_mov_b64 exec, -1
    s_waitcnt lgkmcnt(0)
    s_barrier
    s_bitcmp1_b32 s3, 0
    s_cbranch_scc1 L_conv1
    ds_read_b64_tr_b16 v[136:137], v16 offset:0
    ds_read_b64_tr_b16 v[138:139], v16 offset:16
    ds_read_b128 a[156:159], v8 offset:14336
    ds_read_b128 a[188:191], v9 offset:14336
    ds_read_b128 a[144:147], v8 offset:8192
    ds_read_b128 a[176:179], v9 offset:8192
    ds_read_b128 a[140:143], v8 offset:6144
    ds_read_b128 a[172:175], v9 offset:6144
    ds_read_b128 a[128:131], v8 offset:0
    ds_read_b128 a[160:163], v9 offset:0
    ds_read_b64_tr_b16 v[140:141], v16 offset:512
    ds_read_b64_tr_b16 v[142:143], v16 offset:528
    ds_read_b128 a[152:155], v8 offset:12288
    ds_read_b128 a[184:187], v9 offset:12288
    ds_read_b128 a[136:139], v8 offset:4096
    ds_read_b128 a[168:171], v9 offset:4096
    ds_read_b64_tr_b16 v[144:145], v16 offset:1024
    ds_read_b64_tr_b16 v[146:147], v16 offset:1040
    s_waitcnt lgkmcnt(15)
    v_mfma_f32_16x16x32_bf16 v[104:107], v[136:139], a[156:159], 0
    ds_read_b128 a[148:151], v8 offset:10240
    ds_read_b128 a[180:183], v9 offset:10240
    s_waitcnt lgkmcnt(15)
    v_mfma_f32_16x16x32_bf16 v[108:111], v[136:139], a[188:191], 0
    ds_read_b128 a[132:135], v8 offset:2048
    ds_read_b128 a[164:167], v9 offset:2048
    v_mfma_f32_16x16x32_bf16 v[112:115], v[136:139], a[144:147], 0
    ds_read_b64_tr_b16 v[148:149], v16 offset:1536
    ds_read_b64_tr_b16 v[150:151], v16 offset:1552
    s_waitcnt lgkmcnt(15)
    v_mfma_f32_16x16x32_bf16 v[116:119], v[136:139], a[176:179], 0
    ds_read_b64_tr_b16 v[152:153], v16 offset:2048
    ds_read_b64_tr_b16 v[154:155], v16 offset:2064
    v_mfma_f32_16x16x32_bf16 v[120:123], v[136:139], a[140:143], 0
    ds_read_b64_tr_b16 v[156:157], v16 offset:2560
    ds_read_b64_tr_b16 v[158:159], v16 offset:2576
    v_mfma_f32_16x16x32_bf16 v[124:127], v[136:139], a[172:175], 0
    ds_read_b64_tr_b16 v[160:161], v16 offset:3072
    ds_read_b64_tr_b16 v[162:163], v16 offset:3088
    v_mfma_f32_16x16x32_bf16 v[128:131], v[136:139], a[128:131], 0
    ds_read_b64_tr_b16 v[164:165], v16 offset:3584
    ds_read_b64_tr_b16 v[166:167], v16 offset:3600
    s_waitcnt lgkmcnt(15)
    v_mfma_f32_16x16x32_bf16 v[132:135], v[136:139], a[160:163], 0
    ds_read_b64_tr_b16 v[168:169], v16 offset:128
    ds_read_b64_tr_b16 v[170:171], v16 offset:144
    v_mfma_f32_16x16x32_bf16 v[104:107], v[140:143], a[152:155], v[104:107]
    ds_read_b128 a[220:223], v10 offset:14336
    ds_read_b128 a[252:255], v11 offset:14336
    v_mfma_f32_16x16x32_bf16 v[108:111], v[140:143], a[184:187], v[108:111]
    ds_read_b128 a[208:211], v10 offset:8192
    ds_read_b128 a[240:243], v11 offset:8192
    v_mfma_f32_16x16x32_bf16 v[112:115], v[140:143], a[140:143], v[112:115]
    ds_read_b128 a[204:207], v10 offset:6144
    ds_read_b128 a[236:239], v11 offset:6144
    v_mfma_f32_16x16x32_bf16 v[116:119], v[140:143], a[172:175], v[116:119]
    ds_read_b128 a[192:195], v10 offset:0
    buffer_load_dword v21, v21, s[36:39], s63 offen sc1
    v_mfma_f32_16x16x32_bf16 v[120:123], v[140:143], a[136:139], v[120:123]
    ds_read_b128 a[224:227], v11 offset:0
    v_lshlrev_b32 v44, 4, v0
    v_mfma_f32_16x16x32_bf16 v[124:127], v[140:143], a[168:171], v[124:127]
    ds_read_b64_tr_b16 v[172:173], v16 offset:640
    s_mov_b32 s54, 16848896
    s_waitcnt lgkmcnt(15)
    v_mfma_f32_16x16x32_bf16 v[104:107], v[144:147], a[148:151], v[104:107]
    ds_read_b64_tr_b16 v[174:175], v16 offset:656
    s_mov_b32 s55, 16861184
    v_mfma_f32_16x16x32_bf16 v[108:111], v[144:147], a[180:183], v[108:111]
    ds_read_b128 a[216:219], v10 offset:12288
    s_mov_b32 s56, 16873472
    v_mfma_f32_16x16x32_bf16 v[112:115], v[144:147], a[136:139], v[112:115]
    ds_read_b128 a[248:251], v11 offset:12288
    s_mov_b32 s57, 16885760
    v_mfma_f32_16x16x32_bf16 v[116:119], v[144:147], a[168:171], v[116:119]
    ds_read_b128 a[200:203], v10 offset:4096
    buffer_load_dwordx4 v[24:27], v44, s[36:39], s54 offen sc1
    v_mfma_f32_16x16x32_bf16 v[120:123], v[144:147], a[132:135], v[120:123]
    ds_read_b128 a[232:235], v11 offset:4096
    buffer_load_dwordx4 v[28:31], v44, s[36:39], s55 offen sc1
    v_mfma_f32_16x16x32_bf16 v[124:127], v[144:147], a[164:167], v[124:127]
    ds_read_b64_tr_b16 v[176:177], v16 offset:1152
    buffer_load_dwordx4 v[32:35], v44, s[36:39], s56 offen sc1
    v_mfma_f32_16x16x32_bf16 v[104:107], v[148:151], a[144:147], v[104:107]
    ds_read_b64_tr_b16 v[178:179], v16 offset:1168
    buffer_load_dwordx4 v[36:39], v44, s[36:39], s57 offen sc1
    v_mfma_f32_16x16x32_bf16 v[108:111], v[148:151], a[176:179], v[108:111]
    ds_read_b128 a[212:215], v10 offset:10240
    v_lshlrev_b32 v45, 2, v2
    v_mfma_f32_16x16x32_bf16 v[112:115], v[148:151], a[132:135], v[112:115]
    ds_read_b128 a[244:247], v11 offset:10240
    s_lshl_b32 s58, s93, 8
    v_mfma_f32_16x16x32_bf16 v[116:119], v[148:151], a[164:167], v[116:119]
    ds_read_b128 a[196:199], v10 offset:2048
    s_add_u32 s54, s58, 16852992
    v_mfma_f32_16x16x32_bf16 v[120:123], v[148:151], a[128:131], v[120:123]
    ds_read_b128 a[228:231], v11 offset:2048
    s_add_u32 s55, s58, 16865280
    v_mfma_f32_16x16x32_bf16 v[124:127], v[148:151], a[160:163], v[124:127]
    ds_read_b64_tr_b16 v[180:181], v16 offset:1664
    s_add_u32 s56, s58, 16877568
    v_mfma_f32_16x16x32_bf16 v[104:107], v[152:155], a[140:143], v[104:107]
    ds_read_b64_tr_b16 v[182:183], v16 offset:1680
    s_add_u32 s57, s58, 16889856
    v_mfma_f32_16x16x32_bf16 v[108:111], v[152:155], a[172:175], v[108:111]
    ds_read_b64_tr_b16 v[184:185], v16 offset:2176
    buffer_load_dword v40, v45, s[36:39], s54 offen sc1
    v_mfma_f32_16x16x32_bf16 v[112:115], v[152:155], a[128:131], v[112:115]
    ds_read_b64_tr_b16 v[186:187], v16 offset:2192
    buffer_load_dword v41, v45, s[36:39], s55 offen sc1
    v_mfma_f32_16x16x32_bf16 v[116:119], v[152:155], a[160:163], v[116:119]
    ds_read_b64_tr_b16 v[188:189], v16 offset:2688
    buffer_load_dword v42, v45, s[36:39], s56 offen sc1
    v_mfma_f32_16x16x32_bf16 v[104:107], v[156:159], a[136:139], v[104:107]
    ds_read_b64_tr_b16 v[190:191], v16 offset:2704
    buffer_load_dword v43, v45, s[36:39], s57 offen sc1
    v_mfma_f32_16x16x32_bf16 v[108:111], v[156:159], a[168:171], v[108:111]
    ds_read_b64_tr_b16 v[192:193], v16 offset:3200
    s_add_u32 s98, s94, 3
    s_waitcnt lgkmcnt(15)
    v_mfma_f32_16x16x32_bf16 v[104:107], v[160:163], a[132:135], v[104:107]
    ds_read_b64_tr_b16 v[194:195], v16 offset:3216
    s_lshl_b32 m0, 3, 13
    v_mfma_f32_16x16x32_bf16 v[108:111], v[160:163], a[164:167], v[108:111]
    ds_read_b64_tr_b16 v[196:197], v16 offset:3712
    s_bitcmp1_b32 s98, 2
    s_cselect_b64 vcc, -1, 0
    v_mfma_f32_16x16x32_bf16 v[104:107], v[164:167], a[128:131], v[104:107]
    ds_read_b64_tr_b16 v[198:199], v16 offset:3728
    s_add_u32 m0, m0, s89
    v_mfma_f32_16x16x32_bf16 v[108:111], v[164:167], a[160:163], v[108:111]
    s_and_b32 s98, s98, 3
    v_mfma_f32_16x16x32_bf16 v[104:107], v[168:171], a[220:223], v[104:107]
    ds_read_b64_tr_b16 v[136:137], v16 offset:256
    v_cndmask_b32 v245, v236, v237, vcc
    v_mfma_f32_16x16x32_bf16 v[108:111], v[168:171], a[252:255], v[108:111]
    ds_read_b64_tr_b16 v[138:139], v16 offset:272
    v_add_u32 v224, v245, v238
    v_mfma_f32_16x16x32_bf16 v[112:115], v[168:171], a[208:211], v[112:115]
    ds_read_b128 a[156:159], v12 offset:14336
    v_add_u32 v225, v245, v239
    v_mfma_f32_16x16x32_bf16 v[116:119], v[168:171], a[240:243], v[116:119]
    ds_read_b128 a[188:191], v13 offset:14336
    v_add_u32 v226, v245, v240
    v_mfma_f32_16x16x32_bf16 v[120:123], v[168:171], a[204:207], v[120:123]
    ds_read_b128 a[144:147], v12 offset:8192
    v_add_u32 v227, v245, v241
    v_mfma_f32_16x16x32_bf16 v[124:127], v[168:171], a[236:239], v[124:127]
    ds_read_b128 a[176:179], v13 offset:8192
    s_mul_i32 s86, s98, 229376
    v_mfma_f32_16x16x32_bf16 v[128:131], v[168:171], a[192:195], v[128:131]
    ds_read_b128 a[140:143], v12 offset:6144
    s_lshl_b32 s98, s88, 8
    v_mfma_f32_16x16x32_bf16 v[132:135], v[168:171], a[224:227], v[132:135]
    ds_read_b128 a[172:175], v13 offset:6144
    s_add_u32 s86, s86, s98
    v_mfma_f32_16x16x32_bf16 v[104:107], v[172:175], a[216:219], v[104:107]
    ds_read_b128 a[128:131], v12 offset:0
    s_lshl_b32 s98, s3, 6
    v_mfma_f32_16x16x32_bf16 v[108:111], v[172:175], a[248:251], v[108:111]
    ds_read_b128 a[160:163], v13 offset:0
    s_add_u32 s86, s86, s98
    v_mfma_f32_16x16x32_bf16 v[112:115], v[172:175], a[204:207], v[112:115]
    ds_read_b64_tr_b16 v[140:141], v16 offset:768
    buffer_load_dwordx4 v224, s[20:23], s86 offen offset:0 lds
    v_mfma_f32_16x16x32_bf16 v[116:119], v[172:175], a[236:239], v[116:119]
    ds_read_b64_tr_b16 v[142:143], v16 offset:784
    buffer_load_dwordx4 v225, s[20:23], s86 offen offset:1024 lds
    s_waitcnt lgkmcnt(15)
    v_mfma_f32_16x16x32_bf16 v[120:123], v[172:175], a[200:203], v[120:123]
    ds_read_b128 a[152:155], v12 offset:12288
    buffer_load_dwordx4 v226, s[20:23], s86 offen offset:2048 lds
    v_mfma_f32_16x16x32_bf16 v[124:127], v[172:175], a[232:235], v[124:127]
    ds_read_b128 a[184:187], v13 offset:12288
    buffer_load_dwordx4 v227, s[20:23], s86 offen offset:3072 lds
    v_mfma_f32_16x16x32_bf16 v[104:107], v[176:179], a[212:215], v[104:107]
    ds_read_b128 a[136:139], v12 offset:4096
    s_add_u32 m0, m0, 4096
    v_mfma_f32_16x16x32_bf16 v[108:111], v[176:179], a[244:247], v[108:111]
    ds_read_b128 a[168:171], v13 offset:4096
    s_add_u32 s86, s86, 114688
    v_mfma_f32_16x16x32_bf16 v[112:115], v[176:179], a[200:203], v[112:115]
    ds_read_b64_tr_b16 v[144:145], v16 offset:1280
    buffer_load_dwordx4 v224, s[20:23], s86 offen offset:0 lds
    v_mfma_f32_16x16x32_bf16 v[116:119], v[176:179], a[232:235], v[116:119]
    ds_read_b64_tr_b16 v[146:147], v16 offset:1296
    buffer_load_dwordx4 v225, s[20:23], s86 offen offset:1024 lds
    v_mfma_f32_16x16x32_bf16 v[120:123], v[176:179], a[196:199], v[120:123]
    ds_read_b128 a[148:151], v12 offset:10240
    buffer_load_dwordx4 v226, s[20:23], s86 offen offset:2048 lds
    v_mfma_f32_16x16x32_bf16 v[124:127], v[176:179], a[228:231], v[124:127]
    ds_read_b128 a[180:183], v13 offset:10240
    buffer_load_dwordx4 v227, s[20:23], s86 offen offset:3072 lds
    v_mfma_f32_16x16x32_bf16 v[104:107], v[180:183], a[208:211], v[104:107]
    ds_read_b128 a[132:135], v12 offset:2048
    s_add_u32 s98, s91, 0
    v_mfma_f32_16x16x32_bf16 v[108:111], v[180:183], a[240:243], v[108:111]
    ds_read_b128 a[164:167], v13 offset:2048
    s_add_u32 m0, s89, 0
    v_mfma_f32_16x16x32_bf16 v[112:115], v[180:183], a[196:199], v[112:115]
    ds_read_b64_tr_b16 v[148:149], v16 offset:1792
    s_cmp_ge_u32 s98, 7
    s_cselect_b32 s86, 7, 0
    v_mfma_f32_16x16x32_bf16 v[116:119], v[180:183], a[228:231], v[116:119]
    ds_read_b64_tr_b16 v[150:151], v16 offset:1808
    s_sub_u32 s98, s98, s86
    v_mfma_f32_16x16x32_bf16 v[120:123], v[180:183], a[192:195], v[120:123]
    ds_read_b64_tr_b16 v[152:153], v16 offset:2304
    s_lshl_b32 s86, s98, 16
    v_mfma_f32_16x16x32_bf16 v[124:127], v[180:183], a[224:227], v[124:127]
    ds_read_b64_tr_b16 v[154:155], v16 offset:2320
    s_add_u32 s86, s86, s90
    v_mfma_f32_16x16x32_bf16 v[104:107], v[184:187], a[204:207], v[104:107]
    ds_read_b64_tr_b16 v[156:157], v16 offset:2816
    buffer_load_dwordx4 v228, s[24:27], s86 offen offset:0 lds
    v_mfma_f32_16x16x32_bf16 v[108:111], v[184:187], a[236:239], v[108:111]
    ds_read_b64_tr_b16 v[158:159], v16 offset:2832
    buffer_load_dwordx4 v229, s[24:27], s86 offen offset:1024 lds
    v_mfma_f32_16x16x32_bf16 v[112:115], v[184:187], a[192:195], v[112:115]
    ds_read_b64_tr_b16 v[160:161], v16 offset:3328
    buffer_load_dwordx4 v230, s[24:27], s86 offen offset:2048 lds
    v_mfma_f32_16x16x32_bf16 v[116:119], v[184:187], a[224:227], v[116:119]
    ds_read_b64_tr_b16 v[162:163], v16 offset:3344
    buffer_load_dwordx4 v231, s[24:27], s86 offen offset:3072 lds
    v_mfma_f32_16x16x32_bf16 v[104:107], v[188:191], a[200:203], v[104:107]
    ds_read_b64_tr_b16 v[164:165], v16 offset:3840
    s_add_u32 m0, m0, 4096
    v_mfma_f32_16x16x32_bf16 v[108:111], v[188:191], a[232:235], v[108:111]
    ds_read_b64_tr_b16 v[166:167], v16 offset:3856
    s_add_u32 s86, s86, 32768
    s_waitcnt lgkmcnt(15)
    v_mfma_f32_16x16x32_bf16 v[104:107], v[192:195], a[196:199], v[104:107]
    buffer_load_dwordx4 v228, s[24:27], s86 offen offset:0 lds
    v_mfma_f32_16x16x32_bf16 v[108:111], v[192:195], a[228:231], v[108:111]
    buffer_load_dwordx4 v229, s[24:27], s86 offen offset:1024 lds
    v_mfma_f32_16x16x32_bf16 v[104:107], v[196:199], a[192:195], v[104:107]
    buffer_load_dwordx4 v230, s[24:27], s86 offen offset:2048 lds
    v_mfma_f32_16x16x32_bf16 v[108:111], v[196:199], a[224:227], v[108:111]
    buffer_load_dwordx4 v231, s[24:27], s86 offen offset:3072 lds
    s_waitcnt vmcnt(24)
    v_add_f32_dpp v21, v21, v21 quad_perm:[1,0,3,2] row_mask:0xf bank_mask:0xf
    v_lshlrev_b32 v1, 16, v22
    s_nop 0
    v_add_f32_dpp v21, v21, v21 quad_perm:[2,3,0,1] row_mask:0xf bank_mask:0xf
    v_cvt_pk_bf16_f32 v21, v21, v21
    v_lshlrev_b32 v21, 16, v21
    v_add_f32 v5, 1.0, v21
    v_cvt_pk_bf16_f32 v5, v5, v5
    v_lshlrev_b32 v5, 16, v5
    v_readlane_b32 s70, v21, 0
    v_readlane_b32 s72, v21, 8
    v_readlane_b32 s71, v5, 4
    v_readlane_b32 s73, v5, 12
    v_mov_b32 v5, s72
    v_mul_f32 v7, s71, v5
    v_mul_f32 v21, s70, v5
    v_mov_b32 v217, s73
    s_lshr_b32 s59, s3, 1
    v_cvt_f32_u32 v46, s59
    s_xor_b32 s59, s59, 1
    s_lshl_b32 s59, s59, 10
    s_add_u32 s59, s59, 147968
    s_lshl_b32 s58, s94, 7
    v_lshrrev_b32 v44, 1, v44
    v_subrev_u32 v44, s58, v44
    v_and_b32 v44, 0x3ff, v44
    v_add_u32 v44, s59, v44
    s_waitcnt vmcnt(22)
    v_add_f32 v24, v24, v28
    s_waitcnt vmcnt(20)
    v_add_f32 v32, v32, v36
    v_add_f32 v25, v25, v29
    v_add_f32 v33, v33, v37
    v_add_f32 v26, v26, v30
    v_add_f32 v34, v34, v38
    v_add_f32 v27, v27, v31
    v_add_f32 v35, v35, v39
    v_add_f32 v24, v24, v32
    v_add_f32 v25, v25, v33
    v_add_f32 v26, v26, v34
    v_add_f32 v27, v27, v35
    s_waitcnt vmcnt(18)
    v_add_f32 v40, v40, v41
    s_waitcnt vmcnt(16)
    v_add_f32 v42, v42, v43
    v_cvt_pk_bf16_f32 v28, v24, v25
    v_cvt_pk_bf16_f32 v29, v26, v27
    v_add_f32 v40, v40, v42
    v_lshlrev_b32 v24, 16, v28
    v_and_b32 v25, 0xffff0000, v28
    v_lshlrev_b32 v26, 16, v29
    v_and_b32 v27, 0xffff0000, v29
    v_cvt_pk_bf16_f32 v40, v40, v40
    v_add_f32 v24, v46, v24
    v_add_f32 v25, v46, v25
    v_add_f32 v26, v46, v26
    v_add_f32 v27, v46, v27
    v_lshlrev_b32 v40, 16, v40
    v_cvt_pk_bf16_f32 v28, v24, v25
    v_cvt_pk_bf16_f32 v29, v26, v27
    v_mul_f32 v40, 0xbf317218, v40
    ds_write_b64 v44, v[28:29]
    v_add_u32 v45, 152960, v45
    ds_write_b32 v45, v40
    v_mov_b32 v41, 0
    v_and_b32 v42, 60, v45
    v_add_u32 v42, 150016, v42
    ds_write_b32 v42, v41
    s_barrier
    v_mfma_f32_16x16x32_bf16 v[104:107], v[136:139], a[156:159], v[104:107]
    ds_read_b64_tr_b16 v[168:169], v16 offset:384
    s_add_u32 s98, s91, 1
    v_mfma_f32_16x16x32_bf16 v[108:111], v[136:139], a[188:191], v[108:111]
    ds_read_b64_tr_b16 v[170:171], v16 offset:400
    s_add_u32 m0, s89, 8192
    v_mfma_f32_16x16x32_bf16 v[112:115], v[136:139], a[144:147], v[112:115]
    ds_read_b128 a[252:255], v15 offset:14336
    s_cmp_ge_u32 s98, 7
    s_cselect_b32 s86, 7, 0
    v_mfma_f32_16x16x32_bf16 v[116:119], v[136:139], a[176:179], v[116:119]
    ds_read_b128 a[240:243], v15 offset:8192
    s_sub_u32 s98, s98, s86
    v_mfma_f32_16x16x32_bf16 v[120:123], v[136:139], a[140:143], v[120:123]
    ds_read_b128 a[236:239], v15 offset:6144
    ds_read_b32 v200, v17 offset:14336
    v_mfma_f32_16x16x32_bf16 v[124:127], v[136:139], a[172:175], v[124:127]
    ds_read_b128 a[224:227], v15 offset:0
    s_lshl_b32 s86, s98, 16
    v_mfma_f32_16x16x32_bf16 v[128:131], v[136:139], a[128:131], v[128:131]
    ds_read_b64_tr_b16 v[172:173], v16 offset:896
    ds_read_b32 v201, v18 offset:14336
    v_mfma_f32_16x16x32_bf16 v[132:135], v[136:139], a[160:163], v[132:135]
    ds_read_b64_tr_b16 v[174:175], v16 offset:912
    s_add_u32 s86, s86, s90
    v_mfma_f32_16x16x32_bf16 v[104:107], v[140:143], a[152:155], v[104:107]
    ds_read_b128 a[248:251], v15 offset:12288
    buffer_load_dwordx4 v228, s[24:27], s86 offen offset:0 lds
    v_mfma_f32_16x16x32_bf16 v[108:111], v[140:143], a[184:187], v[108:111]
    ds_read_b128 a[232:235], v15 offset:4096
    ds_read_b32 v202, v19 offset:14336
    v_mfma_f32_16x16x32_bf16 v[112:115], v[140:143], a[140:143], v[112:115]
    ds_read_b64_tr_b16 v[176:177], v16 offset:1408
    buffer_load_dwordx4 v229, s[24:27], s86 offen offset:1024 lds
    v_mfma_f32_16x16x32_bf16 v[116:119], v[140:143], a[172:175], v[116:119]
    ds_read_b64_tr_b16 v[178:179], v16 offset:1424
    ds_read_b32 v203, v20 offset:14336
    v_mfma_f32_16x16x32_bf16 v[120:123], v[140:143], a[136:139], v[120:123]
    ds_read_b128 a[244:247], v15 offset:10240
    buffer_load_dwordx4 v230, s[24:27], s86 offen offset:2048 lds
    v_mfma_f32_16x16x32_bf16 v[124:127], v[140:143], a[168:171], v[124:127]
    ds_read_b128 a[228:231], v15 offset:2048
    buffer_load_dwordx4 v231, s[24:27], s86 offen offset:3072 lds
    s_waitcnt lgkmcnt(15)
    v_mfma_f32_16x16x32_bf16 v[104:107], v[144:147], a[148:151], v[104:107]
    ds_read_b64_tr_b16 v[180:181], v16 offset:1920
    ds_read_b128 v[24:27], v23 offset:40704
    v_mfma_f32_16x16x32_bf16 v[108:111], v[144:147], a[180:183], v[108:111]
    ds_read_b64_tr_b16 v[182:183], v16 offset:1936
    s_add_u32 m0, m0, 4096
    v_mfma_f32_16x16x32_bf16 v[112:115], v[144:147], a[136:139], v[112:115]
    ds_read_b64_tr_b16 v[184:185], v16 offset:2432
    ds_read_b128 v[40:43], v216 offset:40704
    v_mfma_f32_16x16x32_bf16 v[116:119], v[144:147], a[168:171], v[116:119]
    ds_read_b64_tr_b16 v[186:187], v16 offset:2448
    s_add_u32 s86, s86, 32768
    v_mfma_f32_16x16x32_bf16 v[120:123], v[144:147], a[132:135], v[120:123]
    ds_read_b64_tr_b16 v[188:189], v16 offset:2944
    ds_read_b32 v204, v17 offset:8192
    v_mfma_f32_16x16x32_bf16 v[124:127], v[144:147], a[164:167], v[124:127]
    ds_read_b64_tr_b16 v[190:191], v16 offset:2960
    buffer_load_dwordx4 v228, s[24:27], s86 offen offset:0 lds
    v_mfma_f32_16x16x32_bf16 v[104:107], v[148:151], a[144:147], v[104:107]
    ds_read_b64_tr_b16 v[192:193], v16 offset:3456
    buffer_load_dwordx4 v229, s[24:27], s86 offen offset:1024 lds
    v_mfma_f32_16x16x32_bf16 v[108:111], v[148:151], a[176:179], v[108:111]
    ds_read_b64_tr_b16 v[194:195], v16 offset:3472
    ds_read_b32 v205, v18 offset:8192
    v_mfma_f32_16x16x32_bf16 v[112:115], v[148:151], a[132:135], v[112:115]
    ds_read_b64_tr_b16 v[196:197], v16 offset:3968
    buffer_load_dwordx4 v230, s[24:27], s86 offen offset:2048 lds
    v_mfma_f32_16x16x32_bf16 v[116:119], v[148:151], a[164:167], v[116:119]
    ds_read_b64_tr_b16 v[198:199], v16 offset:3984
    ds_read_b32 v206, v19 offset:8192
    v_mfma_f32_16x16x32_bf16 v[120:123], v[148:151], a[128:131], v[120:123]
    ds_read_b128 a[220:223], v14 offset:14336
    buffer_load_dwordx4 v231, s[24:27], s86 offen offset:3072 lds
    v_mfma_f32_16x16x32_bf16 v[124:127], v[148:151], a[160:163], v[124:127]
    ds_read_b128 a[208:211], v14 offset:8192
    s_add_u32 s98, s91, 2
    v_mfma_f32_16x16x32_bf16 v[104:107], v[152:155], a[140:143], v[104:107]
    ds_read_b128 a[204:207], v14 offset:6144
    ds_read_b32 v207, v20 offset:8192
    v_mfma_f32_16x16x32_bf16 v[108:111], v[152:155], a[172:175], v[108:111]
    ds_read_b128 a[192:195], v14 offset:0
    s_add_u32 m0, s89, 16384
    v_mfma_f32_16x16x32_bf16 v[112:115], v[152:155], a[128:131], v[112:115]
    ds_read_b128 a[216:219], v14 offset:12288
    ds_read_b128 v[28:31], v23 offset:8192
    v_mfma_f32_16x16x32_bf16 v[116:119], v[152:155], a[160:163], v[116:119]
    ds_read_b128 a[200:203], v14 offset:4096
    s_cmp_ge_u32 s98, 7
    s_cselect_b32 s86, 7, 0
    v_mfma_f32_16x16x32_bf16 v[104:107], v[156:159], a[136:139], v[104:107]
    ds_read_b128 a[212:215], v14 offset:10240
    s_sub_u32 s98, s98, s86
    v_mfma_f32_16x16x32_bf16 v[108:111], v[156:159], a[168:171], v[108:111]
    ds_read_b128 a[196:199], v14 offset:2048
    ds_read_b128 v[44:47], v216 offset:8192
    v_mfma_f32_16x16x32_bf16 v[104:107], v[160:163], a[132:135], v[104:107]
    s_lshl_b32 s86, s98, 16
    v_mfma_f32_16x16x32_bf16 v[108:111], v[160:163], a[164:167], v[108:111]
    ds_read_b32 v208, v17 offset:6144
    v_mfma_f32_16x16x32_bf16 v[104:107], v[164:167], a[128:131], v[104:107]
    s_add_u32 s86, s86, s90
    v_mfma_f32_16x16x32_bf16 v[108:111], v[164:167], a[160:163], v[108:111]
    ds_read_b32 v209, v18 offset:6144
    v_mfma_f32_16x16x32_bf16 v[108:111], v[168:171], a[252:255], v[108:111]
    buffer_load_dwordx4 v228, s[24:27], s86 offen offset:0 lds
    ds_read_b32 v210, v19 offset:6144
    s_waitcnt lgkmcnt(15)
    v_mfma_f32_16x16x32_bf16 v[116:119], v[168:171], a[240:243], v[116:119]
    buffer_load_dwordx4 v229, s[24:27], s86 offen offset:1024 lds
    ds_read_b32 v211, v20 offset:6144
    v_mfma_f32_16x16x32_bf16 v[124:127], v[168:171], a[236:239], v[124:127]
    ds_read_b128 v[32:35], v23 offset:6144
    ds_read_b128 v[48:51], v216 offset:6144
    v_mfma_f32_16x16x32_bf16 v[132:135], v[168:171], a[224:227], v[132:135]
    buffer_load_dwordx4 v230, s[24:27], s86 offen offset:2048 lds
    ds_read_b32 v212, v17 offset:0
    v_mfma_f32_16x16x32_bf16 v[108:111], v[172:175], a[248:251], v[108:111]
    ds_read_b32 v213, v18 offset:0
    ds_read_b32 v214, v19 offset:0
    v_mfma_f32_16x16x32_bf16 v[116:119], v[172:175], a[236:239], v[116:119]
    buffer_load_dwordx4 v231, s[24:27], s86 offen offset:3072 lds
    ds_read_b32 v215, v20 offset:0
    v_mfma_f32_16x16x32_bf16 v[124:127], v[172:175], a[232:235], v[124:127]
    s_add_u32 m0, m0, 4096
    ds_read_b128 v[36:39], v23 offset:0
    v_mfma_f32_16x16x32_bf16 v[108:111], v[176:179], a[244:247], v[108:111]
    ds_read_b128 v[52:55], v216 offset:0
    s_waitcnt lgkmcnt(15)
    v_mfma_f32_16x16x32_bf16 v[116:119], v[176:179], a[232:235], v[116:119]
    s_add_u32 s86, s86, 32768
    v_and_b32 v88, 0xffff0000, v202
    v_mfma_f32_16x16x32_bf16 v[124:127], v[176:179], a[228:231], v[124:127]
    v_and_b32 v89, 0xffff0000, v203
    v_lshlrev_b32 v90, 16, v202
    v_mfma_f32_16x16x32_bf16 v[108:111], v[180:183], a[240:243], v[108:111]
    buffer_load_dwordx4 v228, s[24:27], s86 offen offset:0 lds
    v_lshlrev_b32 v91, 16, v203
    v_mfma_f32_16x16x32_bf16 v[116:119], v[180:183], a[228:231], v[116:119]
    buffer_load_dwordx4 v229, s[24:27], s86 offen offset:1024 lds
    v_fma_f32 v72, v88, v24, v40
    v_mfma_f32_16x16x32_bf16 v[124:127], v[180:183], a[224:227], v[124:127]
    v_fma_f32 v73, v89, v25, v41
    v_fma_f32 v74, v90, v26, v42
    v_mfma_f32_16x16x32_bf16 v[108:111], v[184:187], a[236:239], v[108:111]
    buffer_load_dwordx4 v230, s[24:27], s86 offen offset:2048 lds
    v_fma_f32 v75, v91, v27, v43
    v_mfma_f32_16x16x32_bf16 v[116:119], v[184:187], a[224:227], v[116:119]
    v_fma_f32 v72, v72, v7, v21
    v_fma_f32 v73, v73, v7, v21
    v_mfma_f32_16x16x32_bf16 v[108:111], v[188:191], a[232:235], v[108:111]
    buffer_load_dwordx4 v231, s[24:27], s86 offen offset:3072 lds
    v_fma_f32 v74, v74, v7, v21
    v_mfma_f32_16x16x32_bf16 v[108:111], v[192:195], a[228:231], v[108:111]
    v_fma_f32 v75, v75, v7, v21
    v_and_b32 v92, 0xffff0000, v206
    v_mfma_f32_16x16x32_bf16 v[108:111], v[196:199], a[224:227], v[108:111]
    v_and_b32 v93, 0xffff0000, v207
    v_lshlrev_b32 v94, 16, v206
    v_mfma_f32_16x16x32_bf16 v[104:107], v[168:171], a[220:223], v[104:107]
    v_lshlrev_b32 v95, 16, v207
    s_waitcnt lgkmcnt(12)
    v_fma_f32 v76, v92, v28, v44
    v_mfma_f32_16x16x32_bf16 v[112:115], v[168:171], a[208:211], v[112:115]
    v_fma_f32 v77, v93, v29, v45
    v_fma_f32 v78, v94, v30, v46
    v_mfma_f32_16x16x32_bf16 v[120:123], v[168:171], a[204:207], v[120:123]
    v_fma_f32 v79, v95, v31, v47
    v_fma_f32 v76, v76, v7, v21
    v_mfma_f32_16x16x32_bf16 v[128:131], v[168:171], a[192:195], v[128:131]
    v_fma_f32 v77, v77, v7, v21
    ds_write_b32 v218, v111 offset:1796
    ds_write_b32 v218, v119 offset:1028
    ds_write_b32 v218, v127 offset:772
    ds_write_b32 v218, v135 offset:4
    v_mfma_f32_16x16x32_bf16 v[104:107], v[172:175], a[216:219], v[104:107]
    v_fma_f32 v78, v78, v7, v21
    v_fma_f32 v79, v79, v7, v21
    v_mfma_f32_16x16x32_bf16 v[112:115], v[172:175], a[204:207], v[112:115]
    s_waitcnt lgkmcnt(13)
    v_and_b32 v96, 0xffff0000, v210
    s_waitcnt lgkmcnt(12)
    v_and_b32 v97, 0xffff0000, v211
    v_mfma_f32_16x16x32_bf16 v[120:123], v[172:175], a[200:203], v[120:123]
    v_lshlrev_b32 v98, 16, v210
    s_waitcnt lgkmcnt(0)
    s_barrier
    ds_read_b32 v56, v218 offset:1792
    ds_read_b32 v57, v218 offset:1024
    ds_read_b32 v58, v218 offset:768
    ds_read_b32 v59, v218 offset:0
    v_mfma_f32_16x16x32_bf16 v[104:107], v[176:179], a[212:215], v[104:107]
    v_lshlrev_b32 v99, 16, v211
    s_add_u32 s98, s94, s3
    s_lshl_b32 m0, s3, 13
    v_mfma_f32_16x16x32_bf16 v[112:115], v[176:179], a[200:203], v[112:115]
    v_fma_f32 v80, v96, v32, v48
    s_bitcmp1_b32 s98, 2
    s_cselect_b64 vcc, -1, 0
    s_add_u32 m0, m0, 98304
    v_mfma_f32_16x16x32_bf16 v[120:123], v[176:179], a[196:199], v[120:123]
    v_fma_f32 v81, v97, v33, v49
    s_and_b32 s98, s98, 3
    v_cndmask_b32 v245, v236, v237, vcc
    v_mfma_f32_16x16x32_bf16 v[104:107], v[180:183], a[208:211], v[104:107]
    v_fma_f32 v82, v98, v34, v50
    v_add_u32 v60, v245, v238
    v_add_u32 v61, v245, v239
    v_mfma_f32_16x16x32_bf16 v[112:115], v[180:183], a[196:199], v[112:115]
    v_fma_f32 v83, v99, v35, v51
    v_add_u32 v62, v245, v240
    v_add_u32 v63, v245, v241
    v_mfma_f32_16x16x32_bf16 v[120:123], v[180:183], a[192:195], v[120:123]
    v_fma_f32 v80, v80, v7, v21
    s_mul_i32 s86, s98, 229376
    s_lshl_b32 s98, s88, 8
    v_mfma_f32_16x16x32_bf16 v[104:107], v[184:187], a[204:207], v[104:107]
    v_fma_f32 v81, v81, v7, v21
    s_add_u32 s86, s86, s98
    s_lshl_b32 s98, 3, 6
    v_mfma_f32_16x16x32_bf16 v[112:115], v[184:187], a[192:195], v[112:115]
    v_fma_f32 v82, v82, v7, v21
    s_add_u32 s86, s86, s98
    buffer_load_dwordx4 v60, s[20:23], s86 offen offset:0 lds
    v_mfma_f32_16x16x32_bf16 v[104:107], v[188:191], a[200:203], v[104:107]
    v_fma_f32 v83, v83, v7, v21
    buffer_load_dwordx4 v61, s[20:23], s86 offen offset:1024 lds
    buffer_load_dwordx4 v62, s[20:23], s86 offen offset:2048 lds
    v_mfma_f32_16x16x32_bf16 v[104:107], v[192:195], a[196:199], v[104:107]
    v_and_b32 v100, 0xffff0000, v214
    buffer_load_dwordx4 v63, s[20:23], s86 offen offset:3072 lds
    s_add_u32 m0, m0, 4096
    v_mfma_f32_16x16x32_bf16 v[104:107], v[196:199], a[192:195], v[104:107]
    v_and_b32 v101, 0xffff0000, v215
    s_add_u32 s86, s86, 114688
    buffer_load_dwordx4 v60, s[20:23], s86 offen offset:0 lds
    v_lshlrev_b32 v102, 16, v214
    v_lshlrev_b32 v103, 16, v215
    v_fma_f32 v84, v100, v36, v52
    v_fma_f32 v85, v101, v37, v53
    v_fma_f32 v86, v102, v38, v54
    v_fma_f32 v87, v103, v39, v55
    v_fma_f32 v84, v84, v7, v21
    v_fma_f32 v85, v85, v7, v21
    v_fma_f32 v86, v86, v7, v21
    v_fma_f32 v87, v87, v7, v21
    buffer_load_dwordx4 v61, s[20:23], s86 offen offset:1024 lds
    buffer_load_dwordx4 v62, s[20:23], s86 offen offset:2048 lds
    buffer_load_dwordx4 v63, s[20:23], s86 offen offset:3072 lds
    s_waitcnt lgkmcnt(3)
    v_fmac_f32 v88, v72, v56
    v_fmac_f32 v89, v73, v108
    v_fmac_f32 v90, v74, v109
    v_fmac_f32 v91, v75, v110
    s_waitcnt lgkmcnt(2)
    v_fmac_f32 v92, v76, v57
    v_fmac_f32 v93, v77, v116
    v_fmac_f32 v94, v78, v117
    v_fmac_f32 v95, v79, v118
    s_waitcnt lgkmcnt(1)
    v_fmac_f32 v96, v80, v58
    v_fmac_f32 v97, v81, v124
    v_fmac_f32 v98, v82, v125
    v_fmac_f32 v99, v83, v126
    s_waitcnt lgkmcnt(0)
    v_fmac_f32 v100, v84, v59
    v_fmac_f32 v101, v85, v132
    v_fmac_f32 v102, v86, v133
    v_fmac_f32 v103, v87, v134
    v_dot2_f32_bf16 v104, v200, v1, v104
    v_dot2_f32_bf16 v105, v201, v1, v105
    v_dot2_f32_bf16 v106, v200, v22, v106
    v_dot2_f32_bf16 v107, v201, v22, v107
    v_dot2_f32_bf16 v112, v204, v1, v112
    v_dot2_f32_bf16 v113, v205, v1, v113
    v_dot2_f32_bf16 v114, v204, v22, v114
    v_dot2_f32_bf16 v115, v205, v22, v115
    v_dot2_f32_bf16 v120, v208, v1, v120
    v_dot2_f32_bf16 v121, v209, v1, v121
    v_dot2_f32_bf16 v122, v208, v22, v122
    v_dot2_f32_bf16 v123, v209, v22, v123
    v_dot2_f32_bf16 v128, v212, v1, v128
    v_dot2_f32_bf16 v129, v213, v1, v129
    v_dot2_f32_bf16 v130, v212, v22, v130
    v_dot2_f32_bf16 v131, v213, v22, v131
    s_add_u32 s69, s96, 6291456
    s_add_u32 s68, s96, 4194304
    v_pk_fma_f32 v[88:89], v[72:73], v[104:105], v[88:89]
    v_pk_fma_f32 v[90:91], v[74:75], v[106:107], v[90:91]
    v_pk_mul_f32 v[24:25], v[88:89], v[216:217] op_sel:[0,1] op_sel_hi:[1,1]
    v_pk_mul_f32 v[26:27], v[90:91], v[216:217] op_sel:[0,1] op_sel_hi:[1,1]
    v_cvt_pk_bf16_f32 v144, v24, v25
    v_cvt_pk_bf16_f32 v145, v26, v27
    ds_write_b64 v219, v[144:145] offset:0
    v_pk_fma_f32 v[92:93], v[76:77], v[112:113], v[92:93]
    v_pk_fma_f32 v[94:95], v[78:79], v[114:115], v[94:95]
    v_pk_mul_f32 v[28:29], v[92:93], v[216:217] op_sel:[0,1] op_sel_hi:[1,1]
    v_pk_mul_f32 v[30:31], v[94:95], v[216:217] op_sel:[0,1] op_sel_hi:[1,1]
    v_cvt_pk_bf16_f32 v146, v28, v29
    v_cvt_pk_bf16_f32 v147, v30, v31
    ds_write_b64 v219, v[146:147] offset:512
    v_pk_fma_f32 v[96:97], v[80:81], v[120:121], v[96:97]
    v_pk_fma_f32 v[98:99], v[82:83], v[122:123], v[98:99]
    v_pk_mul_f32 v[32:33], v[96:97], v[216:217] op_sel:[0,1] op_sel_hi:[1,1]
    v_pk_mul_f32 v[34:35], v[98:99], v[216:217] op_sel:[0,1] op_sel_hi:[1,1]
    v_cvt_pk_bf16_f32 v148, v32, v33
    v_cvt_pk_bf16_f32 v149, v34, v35
    ds_write_b64 v219, v[148:149] offset:1024
    v_pk_fma_f32 v[100:101], v[84:85], v[128:129], v[100:101]
    v_pk_fma_f32 v[102:103], v[86:87], v[130:131], v[102:103]
    v_pk_mul_f32 v[36:37], v[100:101], v[216:217] op_sel:[0,1] op_sel_hi:[1,1]
    v_pk_mul_f32 v[38:39], v[102:103], v[216:217] op_sel:[0,1] op_sel_hi:[1,1]
    v_cvt_pk_bf16_f32 v150, v36, v37
    v_cvt_pk_bf16_f32 v151, v38, v39
    ds_write_b64 v219, v[150:151] offset:1536
    v_cvt_pk_bf16_f32 v136, v88, v89
    v_cvt_pk_bf16_f32 v137, v90, v91
    ds_write_b64 v219, v[136:137] offset:2048
    v_cvt_pk_bf16_f32 v138, v92, v93
    v_cvt_pk_bf16_f32 v139, v94, v95
    ds_write_b64 v219, v[138:139] offset:2560
    v_cvt_pk_bf16_f32 v140, v96, v97
    v_cvt_pk_bf16_f32 v141, v98, v99
    ds_write_b64 v219, v[140:141] offset:3072
    v_cvt_pk_bf16_f32 v142, v100, v101
    v_cvt_pk_bf16_f32 v143, v102, v103
    ds_write_b64 v219, v[142:143] offset:3584
    s_waitcnt lgkmcnt(4)
    ds_read_b128 v[152:155], v220 offset:0
    ds_read_b128 v[156:159], v220 offset:1024
    s_waitcnt lgkmcnt(2)
    ds_read_b128 v[160:163], v220 offset:2048
    ds_read_b128 v[164:167], v220 offset:3072
    s_waitcnt lgkmcnt(3)
    buffer_store_dwordx4 v[152:155], v221, s[36:39], s69 offen sc1
    s_waitcnt lgkmcnt(2)
    buffer_store_dwordx4 v[156:159], v222, s[36:39], s69 offen sc1
    s_waitcnt lgkmcnt(1)
    buffer_store_dwordx4 v[160:163], v221, s[36:39], s68 offen sc1
    s_waitcnt lgkmcnt(0)
    buffer_store_dwordx4 v[164:167], v222, s[36:39], s68 offen sc1
    s_waitcnt vmcnt(36)
    ds_read_b64_tr_b16 a[48:49], v242 offset:24576
    ds_read_b64_tr_b16 a[50:51], v242 offset:25088
    ds_read_b64_tr_b16 a[112:113], v243 offset:24576
    ds_read_b64_tr_b16 a[114:115], v243 offset:25088
    ds_read_b64_tr_b16 a[52:53], v242 offset:26624
    ds_read_b64_tr_b16 a[54:55], v242 offset:27136
    ds_read_b64_tr_b16 a[116:117], v243 offset:26624
    ds_read_b64_tr_b16 a[118:119], v243 offset:27136
    ds_read_b64_tr_b16 a[56:57], v242 offset:28672
    ds_read_b64_tr_b16 a[58:59], v242 offset:29184
    ds_read_b64_tr_b16 a[120:121], v243 offset:28672
    ds_read_b64_tr_b16 a[122:123], v243 offset:29184
    ds_read_b64_tr_b16 a[60:61], v242 offset:30720
    ds_read_b64_tr_b16 a[62:63], v242 offset:31232
    ds_read_b64_tr_b16 a[124:125], v243 offset:30720
    ds_read_b64_tr_b16 a[126:127], v243 offset:31232
    s_waitcnt lgkmcnt(0)
    s_add_u32 s98, s91, 3
    s_add_u32 m0, s89, 24576
    s_cmp_ge_u32 s98, 7
    s_cselect_b32 s86, 7, 0
    s_sub_u32 s98, s98, s86
    s_lshl_b32 s86, s98, 16
    s_add_u32 s86, s86, s90
    buffer_load_dwordx4 v228, s[24:27], s86 offen offset:0 lds
    buffer_load_dwordx4 v229, s[24:27], s86 offen offset:1024 lds
    buffer_load_dwordx4 v230, s[24:27], s86 offen offset:2048 lds
    buffer_load_dwordx4 v231, s[24:27], s86 offen offset:3072 lds
    s_add_u32 m0, m0, 4096
    s_add_u32 s86, s86, 32768
    buffer_load_dwordx4 v228, s[24:27], s86 offen offset:0 lds
    buffer_load_dwordx4 v229, s[24:27], s86 offen offset:1024 lds
    buffer_load_dwordx4 v230, s[24:27], s86 offen offset:2048 lds
    buffer_load_dwordx4 v231, s[24:27], s86 offen offset:3072 lds
    s_branch L_convdone
L_conv1:
    s_cmp_eq_u32 s3, 3
    s_cbranch_scc1 L_conv3
    ds_read_b64_tr_b16 v[136:137], v16 offset:0
    ds_read_b64_tr_b16 v[138:139], v16 offset:16
    ds_read_b128 a[152:155], v8 offset:12288
    ds_read_b128 a[184:187], v9 offset:12288
    ds_read_b128 a[148:151], v8 offset:10240
    ds_read_b128 a[180:183], v9 offset:10240
    ds_read_b128 a[136:139], v8 offset:4096
    ds_read_b128 a[168:171], v9 offset:4096
    ds_read_b128 a[132:135], v8 offset:2048
    ds_read_b128 a[164:167], v9 offset:2048
    ds_read_b64_tr_b16 v[140:141], v16 offset:512
    ds_read_b64_tr_b16 v[142:143], v16 offset:528
    ds_read_b128 a[144:147], v8 offset:8192
    ds_read_b128 a[176:179], v9 offset:8192
    ds_read_b128 a[128:131], v8 offset:0
    ds_read_b128 a[160:163], v9 offset:0
    ds_read_b64_tr_b16 v[144:145], v16 offset:1024
    ds_read_b64_tr_b16 v[146:147], v16 offset:1040
    s_waitcnt lgkmcnt(15)
    v_mfma_f32_16x16x32_bf16 v[104:107], v[136:139], a[152:155], 0
    ds_read_b128 a[140:143], v8 offset:6144
    ds_read_b128 a[172:175], v9 offset:6144
    s_waitcnt lgkmcnt(15)
    v_mfma_f32_16x16x32_bf16 v[108:111], v[136:139], a[184:187], 0
    ds_read_b64_tr_b16 v[148:149], v16 offset:1536
    ds_read_b64_tr_b16 v[150:151], v16 offset:1552
    v_mfma_f32_16x16x32_bf16 v[112:115], v[136:139], a[148:151], 0
    ds_read_b64_tr_b16 v[152:153], v16 offset:2048
    ds_read_b64_tr_b16 v[154:155], v16 offset:2064
    s_waitcnt lgkmcnt(15)
    v_mfma_f32_16x16x32_bf16 v[116:119], v[136:139], a[180:183], 0
    ds_read_b64_tr_b16 v[156:157], v16 offset:2560
    buffer_load_dword v21, v21, s[36:39], s63 offen sc1
    v_mfma_f32_16x16x32_bf16 v[120:123], v[136:139], a[136:139], 0
    ds_read_b64_tr_b16 v[158:159], v16 offset:2576
    v_lshlrev_b32 v44, 4, v0
    v_mfma_f32_16x16x32_bf16 v[124:127], v[136:139], a[168:171], 0
    ds_read_b64_tr_b16 v[160:161], v16 offset:3072
    s_mov_b32 s54, 16848896
    v_mfma_f32_16x16x32_bf16 v[128:131], v[136:139], a[132:135], 0
    ds_read_b64_tr_b16 v[162:163], v16 offset:3088
    s_mov_b32 s55, 16861184
    s_waitcnt lgkmcnt(15)
    v_mfma_f32_16x16x32_bf16 v[132:135], v[136:139], a[164:167], 0
    ds_read_b64_tr_b16 v[168:169], v16 offset:128
    s_mov_b32 s56, 16873472
    v_mfma_f32_16x16x32_bf16 v[104:107], v[140:143], a[148:151], v[104:107]
    ds_read_b64_tr_b16 v[170:171], v16 offset:144
    s_mov_b32 s57, 16885760
    v_mfma_f32_16x16x32_bf16 v[108:111], v[140:143], a[180:183], v[108:111]
    ds_read_b128 a[216:219], v10 offset:12288
    buffer_load_dwordx4 v[24:27], v44, s[36:39], s54 offen sc1
    v_mfma_f32_16x16x32_bf16 v[112:115], v[140:143], a[144:147], v[112:115]
    ds_read_b128 a[248:251], v11 offset:12288
    buffer_load_dwordx4 v[28:31], v44, s[36:39], s55 offen sc1
    s_waitcnt lgkmcnt(15)
    v_mfma_f32_16x16x32_bf16 v[116:119], v[140:143], a[176:179], v[116:119]
    ds_read_b128 a[212:215], v10 offset:10240
    buffer_load_dwordx4 v[32:35], v44, s[36:39], s56 offen sc1
    v_mfma_f32_16x16x32_bf16 v[120:123], v[140:143], a[132:135], v[120:123]
    ds_read_b128 a[244:247], v11 offset:10240
    buffer_load_dwordx4 v[36:39], v44, s[36:39], s57 offen sc1
    v_mfma_f32_16x16x32_bf16 v[124:127], v[140:143], a[164:167], v[124:127]
    ds_read_b128 a[200:203], v10 offset:4096
    v_lshlrev_b32 v45, 2, v2
    v_mfma_f32_16x16x32_bf16 v[128:131], v[140:143], a[128:131], v[128:131]
    ds_read_b128 a[232:235], v11 offset:4096
    s_lshl_b32 s58, s93, 8
    v_mfma_f32_16x16x32_bf16 v[132:135], v[140:143], a[160:163], v[132:135]
    ds_read_b128 a[196:199], v10 offset:2048
    s_add_u32 s54, s58, 16852992
    s_waitcnt lgkmcnt(15)
    v_mfma_f32_16x16x32_bf16 v[104:107], v[144:147], a[144:147], v[104:107]
    ds_read_b128 a[228:231], v11 offset:2048
    s_add_u32 s55, s58, 16865280
    v_mfma_f32_16x16x32_bf16 v[108:111], v[144:147], a[176:179], v[108:111]
    ds_read_b64_tr_b16 v[172:173], v16 offset:640
    s_add_u32 s56, s58, 16877568
    v_mfma_f32_16x16x32_bf16 v[112:115], v[144:147], a[140:143], v[112:115]
    ds_read_b64_tr_b16 v[174:175], v16 offset:656
    s_add_u32 s57, s58, 16889856
    v_mfma_f32_16x16x32_bf16 v[116:119], v[144:147], a[172:175], v[116:119]
    ds_read_b128 a[208:211], v10 offset:8192
    buffer_load_dword v40, v45, s[36:39], s54 offen sc1
    v_mfma_f32_16x16x32_bf16 v[120:123], v[144:147], a[128:131], v[120:123]
    ds_read_b128 a[240:243], v11 offset:8192
    buffer_load_dword v41, v45, s[36:39], s55 offen sc1
    v_mfma_f32_16x16x32_bf16 v[124:127], v[144:147], a[160:163], v[124:127]
    ds_read_b128 a[192:195], v10 offset:0
    buffer_load_dword v42, v45, s[36:39], s56 offen sc1
    v_mfma_f32_16x16x32_bf16 v[104:107], v[148:151], a[140:143], v[104:107]
    ds_read_b128 a[224:227], v11 offset:0
    buffer_load_dword v43, v45, s[36:39], s57 offen sc1
    v_mfma_f32_16x16x32_bf16 v[108:111], v[148:151], a[172:175], v[108:111]
    ds_read_b64_tr_b16 v[176:177], v16 offset:1152
    s_add_u32 s98, s94, 3
    v_mfma_f32_16x16x32_bf16 v[112:115], v[148:151], a[136:139], v[112:115]
    ds_read_b64_tr_b16 v[178:179], v16 offset:1168
    s_lshl_b32 m0, 3, 13
    v_mfma_f32_16x16x32_bf16 v[116:119], v[148:151], a[168:171], v[116:119]
    ds_read_b128 a[204:207], v10 offset:6144
    s_bitcmp1_b32 s98, 2
    s_cselect_b64 vcc, -1, 0
    s_waitcnt lgkmcnt(15)
    v_mfma_f32_16x16x32_bf16 v[104:107], v[152:155], a[136:139], v[104:107]
    ds_read_b128 a[236:239], v11 offset:6144
    s_add_u32 m0, m0, s89
    v_mfma_f32_16x16x32_bf16 v[108:111], v[152:155], a[168:171], v[108:111]
    ds_read_b64_tr_b16 v[180:181], v16 offset:1664
    s_and_b32 s98, s98, 3
    v_mfma_f32_16x16x32_bf16 v[112:115], v[152:155], a[132:135], v[112:115]
    ds_read_b64_tr_b16 v[182:183], v16 offset:1680
    v_cndmask_b32 v245, v236, v237, vcc
    v_mfma_f32_16x16x32_bf16 v[116:119], v[152:155], a[164:167], v[116:119]
    ds_read_b64_tr_b16 v[184:185], v16 offset:2176
    v_add_u32 v224, v245, v238
    v_mfma_f32_16x16x32_bf16 v[104:107], v[156:159], a[132:135], v[104:107]
    ds_read_b64_tr_b16 v[186:187], v16 offset:2192
    v_add_u32 v225, v245, v239
    v_mfma_f32_16x16x32_bf16 v[108:111], v[156:159], a[164:167], v[108:111]
    ds_read_b64_tr_b16 v[188:189], v16 offset:2688
    v_add_u32 v226, v245, v240
    v_mfma_f32_16x16x32_bf16 v[112:115], v[156:159], a[128:131], v[112:115]
    ds_read_b64_tr_b16 v[190:191], v16 offset:2704
    v_add_u32 v227, v245, v241
    v_mfma_f32_16x16x32_bf16 v[116:119], v[156:159], a[160:163], v[116:119]
    ds_read_b64_tr_b16 v[192:193], v16 offset:3200
    s_mul_i32 s86, s98, 229376
    v_mfma_f32_16x16x32_bf16 v[104:107], v[160:163], a[128:131], v[104:107]
    ds_read_b64_tr_b16 v[194:195], v16 offset:3216
    s_lshl_b32 s98, s88, 8
    v_mfma_f32_16x16x32_bf16 v[108:111], v[160:163], a[160:163], v[108:111]
    s_add_u32 s86, s86, s98
    v_mfma_f32_16x16x32_bf16 v[104:107], v[168:171], a[216:219], v[104:107]
    ds_read_b64_tr_b16 v[136:137], v16 offset:256
    s_lshl_b32 s98, s3, 6
    v_mfma_f32_16x16x32_bf16 v[108:111], v[168:171], a[248:251], v[108:111]
    ds_read_b64_tr_b16 v[138:139], v16 offset:272
    s_add_u32 s86, s86, s98
    s_waitcnt lgkmcnt(15)
    v_mfma_f32_16x16x32_bf16 v[112:115], v[168:171], a[212:215], v[112:115]
    ds_read_b128 a[152:155], v12 offset:12288
    buffer_load_dwordx4 v224, s[20:23], s86 offen offset:0 lds
    v_mfma_f32_16x16x32_bf16 v[116:119], v[168:171], a[244:247], v[116:119]
    ds_read_b128 a[184:187], v13 offset:12288
    buffer_load_dwordx4 v225, s[20:23], s86 offen offset:1024 lds
    v_mfma_f32_16x16x32_bf16 v[120:123], v[168:171], a[200:203], v[120:123]
    ds_read_b128 a[148:151], v12 offset:10240
    buffer_load_dwordx4 v226, s[20:23], s86 offen offset:2048 lds
    v_mfma_f32_16x16x32_bf16 v[124:127], v[168:171], a[232:235], v[124:127]
    ds_read_b128 a[180:183], v13 offset:10240
    buffer_load_dwordx4 v227, s[20:23], s86 offen offset:3072 lds
    v_mfma_f32_16x16x32_bf16 v[128:131], v[168:171], a[196:199], v[128:131]
    ds_read_b128 a[136:139], v12 offset:4096
    s_add_u32 m0, m0, 4096
    v_mfma_f32_16x16x32_bf16 v[132:135], v[168:171], a[228:231], v[132:135]
    ds_read_b128 a[168:171], v13 offset:4096
    s_add_u32 s86, s86, 114688
    v_mfma_f32_16x16x32_bf16 v[104:107], v[172:175], a[212:215], v[104:107]
    ds_read_b128 a[132:135], v12 offset:2048
    buffer_load_dwordx4 v224, s[20:23], s86 offen offset:0 lds
    v_mfma_f32_16x16x32_bf16 v[108:111], v[172:175], a[244:247], v[108:111]
    ds_read_b128 a[164:167], v13 offset:2048
    buffer_load_dwordx4 v225, s[20:23], s86 offen offset:1024 lds
    v_mfma_f32_16x16x32_bf16 v[112:115], v[172:175], a[208:211], v[112:115]
    ds_read_b64_tr_b16 v[140:141], v16 offset:768
    buffer_load_dwordx4 v226, s[20:23], s86 offen offset:2048 lds
    v_mfma_f32_16x16x32_bf16 v[116:119], v[172:175], a[240:243], v[116:119]
    ds_read_b64_tr_b16 v[142:143], v16 offset:784
    buffer_load_dwordx4 v227, s[20:23], s86 offen offset:3072 lds
    v_mfma_f32_16x16x32_bf16 v[120:123], v[172:175], a[196:199], v[120:123]
    ds_read_b128 a[144:147], v12 offset:8192
    s_add_u32 s98, s91, 0
    v_mfma_f32_16x16x32_bf16 v[124:127], v[172:175], a[228:231], v[124:127]
    ds_read_b128 a[176:179], v13 offset:8192
    s_add_u32 m0, s89, 0
    v_mfma_f32_16x16x32_bf16 v[128:131], v[172:175], a[192:195], v[128:131]
    ds_read_b128 a[128:131], v12 offset:0
    s_cmp_ge_u32 s98, 7
    s_cselect_b32 s86, 7, 0
    s_waitcnt lgkmcnt(15)
    v_mfma_f32_16x16x32_bf16 v[132:135], v[172:175], a[224:227], v[132:135]
    ds_read_b128 a[160:163], v13 offset:0
    s_sub_u32 s98, s98, s86
    v_mfma_f32_16x16x32_bf16 v[104:107], v[176:179], a[208:211], v[104:107]
    ds_read_b64_tr_b16 v[144:145], v16 offset:1280
    s_lshl_b32 s86, s98, 16
    v_mfma_f32_16x16x32_bf16 v[108:111], v[176:179], a[240:243], v[108:111]
    ds_read_b64_tr_b16 v[146:147], v16 offset:1296
    s_add_u32 s86, s86, s90
    v_mfma_f32_16x16x32_bf16 v[112:115], v[176:179], a[204:207], v[112:115]
    ds_read_b128 a[140:143], v12 offset:6144
    buffer_load_dwordx4 v228, s[24:27], s86 offen offset:0 lds
    v_mfma_f32_16x16x32_bf16 v[116:119], v[176:179], a[236:239], v[116:119]
    ds_read_b128 a[172:175], v13 offset:6144
    buffer_load_dwordx4 v229, s[24:27], s86 offen offset:1024 lds
    v_mfma_f32_16x16x32_bf16 v[120:123], v[176:179], a[192:195], v[120:123]
    ds_read_b64_tr_b16 v[148:149], v16 offset:1792
    s_waitcnt vmcnt(18)
    v_add_f32_dpp v21, v21, v21 quad_perm:[1,0,3,2] row_mask:0xf bank_mask:0xf
    v_mfma_f32_16x16x32_bf16 v[124:127], v[176:179], a[224:227], v[124:127]
    ds_read_b64_tr_b16 v[150:151], v16 offset:1808
    buffer_load_dwordx4 v230, s[24:27], s86 offen offset:2048 lds
    v_mfma_f32_16x16x32_bf16 v[104:107], v[180:183], a[204:207], v[104:107]
    ds_read_b64_tr_b16 v[152:153], v16 offset:2304
    buffer_load_dwordx4 v231, s[24:27], s86 offen offset:3072 lds
    v_mfma_f32_16x16x32_bf16 v[108:111], v[180:183], a[236:239], v[108:111]
    ds_read_b64_tr_b16 v[154:155], v16 offset:2320
    v_lshlrev_b32 v1, 16, v22
    v_mfma_f32_16x16x32_bf16 v[112:115], v[180:183], a[200:203], v[112:115]
    ds_read_b64_tr_b16 v[156:157], v16 offset:2816
    s_add_u32 m0, m0, 4096
    v_mfma_f32_16x16x32_bf16 v[116:119], v[180:183], a[232:235], v[116:119]
    ds_read_b64_tr_b16 v[158:159], v16 offset:2832
    v_add_f32_dpp v21, v21, v21 quad_perm:[2,3,0,1] row_mask:0xf bank_mask:0xf
    v_mfma_f32_16x16x32_bf16 v[104:107], v[184:187], a[200:203], v[104:107]
    ds_read_b64_tr_b16 v[160:161], v16 offset:3328
    s_add_u32 s86, s86, 32768
    v_mfma_f32_16x16x32_bf16 v[108:111], v[184:187], a[232:235], v[108:111]
    ds_read_b64_tr_b16 v[162:163], v16 offset:3344
    buffer_load_dwordx4 v228, s[24:27], s86 offen offset:0 lds
    v_mfma_f32_16x16x32_bf16 v[112:115], v[184:187], a[196:199], v[112:115]
    v_cvt_pk_bf16_f32 v21, v21, v21
    v_mfma_f32_16x16x32_bf16 v[116:119], v[184:187], a[228:231], v[116:119]
    buffer_load_dwordx4 v229, s[24:27], s86 offen offset:1024 lds
    v_mfma_f32_16x16x32_bf16 v[104:107], v[188:191], a[196:199], v[104:107]
    v_lshlrev_b32 v21, 16, v21
    v_mfma_f32_16x16x32_bf16 v[108:111], v[188:191], a[228:231], v[108:111]
    buffer_load_dwordx4 v230, s[24:27], s86 offen offset:2048 lds
    v_mfma_f32_16x16x32_bf16 v[112:115], v[188:191], a[192:195], v[112:115]
    buffer_load_dwordx4 v231, s[24:27], s86 offen offset:3072 lds
    v_mfma_f32_16x16x32_bf16 v[116:119], v[188:191], a[224:227], v[116:119]
    v_add_f32 v5, 1.0, v21
    v_mfma_f32_16x16x32_bf16 v[104:107], v[192:195], a[192:195], v[104:107]
    s_add_u32 s98, s91, 1
    v_mfma_f32_16x16x32_bf16 v[108:111], v[192:195], a[224:227], v[108:111]
    v_cvt_pk_bf16_f32 v5, v5, v5
    v_lshlrev_b32 v5, 16, v5
    v_readlane_b32 s70, v21, 0
    v_readlane_b32 s72, v21, 8
    v_readlane_b32 s71, v5, 4
    v_readlane_b32 s73, v5, 12
    v_mov_b32 v5, s72
    v_mul_f32 v7, s71, v5
    v_mul_f32 v21, s70, v5
    v_mov_b32 v217, s73
    s_lshr_b32 s59, s3, 1
    v_cvt_f32_u32 v46, s59
    s_xor_b32 s59, s59, 1
    s_lshl_b32 s59, s59, 10
    s_add_u32 s59, s59, 147968
    s_lshl_b32 s58, s94, 7
    v_lshrrev_b32 v44, 1, v44
    v_subrev_u32 v44, s58, v44
    v_and_b32 v44, 0x3ff, v44
    v_add_u32 v44, s59, v44
    s_waitcnt vmcnt(22)
    v_add_f32 v24, v24, v28
    s_waitcnt vmcnt(20)
    v_add_f32 v32, v32, v36
    v_add_f32 v25, v25, v29
    v_add_f32 v33, v33, v37
    v_add_f32 v26, v26, v30
    v_add_f32 v34, v34, v38
    v_add_f32 v27, v27, v31
    v_add_f32 v35, v35, v39
    v_add_f32 v24, v24, v32
    v_add_f32 v25, v25, v33
    v_add_f32 v26, v26, v34
    v_add_f32 v27, v27, v35
    s_waitcnt vmcnt(18)
    v_add_f32 v40, v40, v41
    s_waitcnt vmcnt(16)
    v_add_f32 v42, v42, v43
    v_cvt_pk_bf16_f32 v28, v24, v25
    v_cvt_pk_bf16_f32 v29, v26, v27
    v_add_f32 v40, v40, v42
    v_lshlrev_b32 v24, 16, v28
    v_and_b32 v25, 0xffff0000, v28
    v_lshlrev_b32 v26, 16, v29
    v_and_b32 v27, 0xffff0000, v29
    v_cvt_pk_bf16_f32 v40, v40, v40
    v_add_f32 v24, v46, v24
    v_add_f32 v25, v46, v25
    v_add_f32 v26, v46, v26
    v_add_f32 v27, v46, v27
    v_lshlrev_b32 v40, 16, v40
    v_cvt_pk_bf16_f32 v28, v24, v25
    v_cvt_pk_bf16_f32 v29, v26, v27
    v_mul_f32 v40, 0xbf317218, v40
    ds_write_b64 v44, v[28:29]
    v_add_u32 v45, 152960, v45
    ds_write_b32 v45, v40
    v_mov_b32 v41, 0
    v_and_b32 v42, 60, v45
    v_add_u32 v42, 150016, v42
    ds_write_b32 v42, v41
    s_barrier
    s_waitcnt lgkmcnt(15)
    v_mfma_f32_16x16x32_bf16 v[104:107], v[136:139], a[152:155], v[104:107]
    ds_read_b64_tr_b16 v[168:169], v16 offset:384
    s_add_u32 m0, s89, 8192
    v_mfma_f32_16x16x32_bf16 v[108:111], v[136:139], a[184:187], v[108:111]
    ds_read_b64_tr_b16 v[170:171], v16 offset:400
    ds_read_b32 v200, v17 offset:12288
    v_mfma_f32_16x16x32_bf16 v[112:115], v[136:139], a[148:151], v[112:115]
    ds_read_b128 a[248:251], v15 offset:12288
    s_cmp_ge_u32 s98, 7
    s_cselect_b32 s86, 7, 0
    v_mfma_f32_16x16x32_bf16 v[116:119], v[136:139], a[180:183], v[116:119]
    ds_read_b128 a[244:247], v15 offset:10240
    s_sub_u32 s98, s98, s86
    v_mfma_f32_16x16x32_bf16 v[120:123], v[136:139], a[136:139], v[120:123]
    ds_read_b128 a[232:235], v15 offset:4096
    ds_read_b32 v201, v18 offset:12288
    v_mfma_f32_16x16x32_bf16 v[124:127], v[136:139], a[168:171], v[124:127]
    ds_read_b128 a[228:231], v15 offset:2048
    s_lshl_b32 s86, s98, 16
    v_mfma_f32_16x16x32_bf16 v[128:131], v[136:139], a[132:135], v[128:131]
    ds_read_b64_tr_b16 v[172:173], v16 offset:896
    ds_read_b32 v202, v19 offset:12288
    v_mfma_f32_16x16x32_bf16 v[132:135], v[136:139], a[164:167], v[132:135]
    ds_read_b64_tr_b16 v[174:175], v16 offset:912
    s_add_u32 s86, s86, s90
    v_mfma_f32_16x16x32_bf16 v[104:107], v[140:143], a[148:151], v[104:107]
    ds_read_b128 a[240:243], v15 offset:8192
    buffer_load_dwordx4 v228, s[24:27], s86 offen offset:0 lds
    v_mfma_f32_16x16x32_bf16 v[108:111], v[140:143], a[180:183], v[108:111]
    ds_read_b128 a[224:227], v15 offset:0
    ds_read_b32 v203, v20 offset:12288
    v_mfma_f32_16x16x32_bf16 v[112:115], v[140:143], a[144:147], v[112:115]
    ds_read_b64_tr_b16 v[176:177], v16 offset:1408
    buffer_load_dwordx4 v229, s[24:27], s86 offen offset:1024 lds
    v_mfma_f32_16x16x32_bf16 v[116:119], v[140:143], a[176:179], v[116:119]
    ds_read_b64_tr_b16 v[178:179], v16 offset:1424
    ds_read_b128 v[24:27], v23 offset:12288
    v_mfma_f32_16x16x32_bf16 v[120:123], v[140:143], a[132:135], v[120:123]
    ds_read_b128 a[236:239], v15 offset:6144
    buffer_load_dwordx4 v230, s[24:27], s86 offen offset:2048 lds
    v_mfma_f32_16x16x32_bf16 v[124:127], v[140:143], a[164:167], v[124:127]
    ds_read_b64_tr_b16 v[180:181], v16 offset:1920
    buffer_load_dwordx4 v231, s[24:27], s86 offen offset:3072 lds
    v_mfma_f32_16x16x32_bf16 v[128:131], v[140:143], a[128:131], v[128:131]
    ds_read_b64_tr_b16 v[182:183], v16 offset:1936
    ds_read_b128 v[40:43], v216 offset:12288
    v_mfma_f32_16x16x32_bf16 v[132:135], v[140:143], a[160:163], v[132:135]
    ds_read_b64_tr_b16 v[184:185], v16 offset:2432
    s_add_u32 m0, m0, 4096
    s_waitcnt lgkmcnt(15)
    v_mfma_f32_16x16x32_bf16 v[104:107], v[144:147], a[144:147], v[104:107]
    ds_read_b64_tr_b16 v[186:187], v16 offset:2448
    ds_read_b32 v204, v17 offset:10240
    v_mfma_f32_16x16x32_bf16 v[108:111], v[144:147], a[176:179], v[108:111]
    ds_read_b64_tr_b16 v[188:189], v16 offset:2944
    s_add_u32 s86, s86, 32768
    v_mfma_f32_16x16x32_bf16 v[112:115], v[144:147], a[140:143], v[112:115]
    ds_read_b64_tr_b16 v[190:191], v16 offset:2960
    ds_read_b32 v205, v18 offset:10240
    v_mfma_f32_16x16x32_bf16 v[116:119], v[144:147], a[172:175], v[116:119]
    ds_read_b64_tr_b16 v[192:193], v16 offset:3456
    buffer_load_dwordx4 v228, s[24:27], s86 offen offset:0 lds
    v_mfma_f32_16x16x32_bf16 v[120:123], v[144:147], a[128:131], v[120:123]
    ds_read_b64_tr_b16 v[194:195], v16 offset:3472
    buffer_load_dwordx4 v229, s[24:27], s86 offen offset:1024 lds
    v_mfma_f32_16x16x32_bf16 v[124:127], v[144:147], a[160:163], v[124:127]
    ds_read_b128 a[216:219], v14 offset:12288
    ds_read_b32 v206, v19 offset:10240
    v_mfma_f32_16x16x32_bf16 v[104:107], v[148:151], a[140:143], v[104:107]
    ds_read_b128 a[212:215], v14 offset:10240
    buffer_load_dwordx4 v230, s[24:27], s86 offen offset:2048 lds
    v_mfma_f32_16x16x32_bf16 v[108:111], v[148:151], a[172:175], v[108:111]
    ds_read_b128 a[200:203], v14 offset:4096
    ds_read_b32 v207, v20 offset:10240
    v_mfma_f32_16x16x32_bf16 v[112:115], v[148:151], a[136:139], v[112:115]
    ds_read_b128 a[196:199], v14 offset:2048
    buffer_load_dwordx4 v231, s[24:27], s86 offen offset:3072 lds
    v_mfma_f32_16x16x32_bf16 v[116:119], v[148:151], a[168:171], v[116:119]
    ds_read_b128 a[208:211], v14 offset:8192
    s_add_u32 s98, s91, 2
    v_mfma_f32_16x16x32_bf16 v[104:107], v[152:155], a[136:139], v[104:107]
    ds_read_b128 a[192:195], v14 offset:0
    ds_read_b128 v[28:31], v23 offset:10240
    v_mfma_f32_16x16x32_bf16 v[108:111], v[152:155], a[168:171], v[108:111]
    ds_read_b128 a[204:207], v14 offset:6144
    s_add_u32 m0, s89, 16384
    v_mfma_f32_16x16x32_bf16 v[112:115], v[152:155], a[132:135], v[112:115]
    ds_read_b128 v[44:47], v216 offset:10240
    v_mfma_f32_16x16x32_bf16 v[116:119], v[152:155], a[164:167], v[116:119]
    s_cmp_ge_u32 s98, 7
    s_cselect_b32 s86, 7, 0
    v_mfma_f32_16x16x32_bf16 v[104:107], v[156:159], a[132:135], v[104:107]
    s_sub_u32 s98, s98, s86
    v_mfma_f32_16x16x32_bf16 v[108:111], v[156:159], a[164:167], v[108:111]
    ds_read_b32 v208, v17 offset:4096
    v_mfma_f32_16x16x32_bf16 v[112:115], v[156:159], a[128:131], v[112:115]
    s_lshl_b32 s86, s98, 16
    v_mfma_f32_16x16x32_bf16 v[116:119], v[156:159], a[160:163], v[116:119]
    ds_read_b32 v209, v18 offset:4096
    v_mfma_f32_16x16x32_bf16 v[104:107], v[160:163], a[128:131], v[104:107]
    s_add_u32 s86, s86, s90
    v_mfma_f32_16x16x32_bf16 v[108:111], v[160:163], a[160:163], v[108:111]
    ds_read_b32 v210, v19 offset:4096
    v_mfma_f32_16x16x32_bf16 v[108:111], v[168:171], a[248:251], v[108:111]
    buffer_load_dwordx4 v228, s[24:27], s86 offen offset:0 lds
    ds_read_b32 v211, v20 offset:4096
    v_mfma_f32_16x16x32_bf16 v[116:119], v[168:171], a[244:247], v[116:119]
    buffer_load_dwordx4 v229, s[24:27], s86 offen offset:1024 lds
    ds_read_b128 v[32:35], v23 offset:4096
    v_mfma_f32_16x16x32_bf16 v[124:127], v[168:171], a[232:235], v[124:127]
    ds_read_b128 v[48:51], v216 offset:4096
    ds_read_b32 v212, v17 offset:2048
    s_waitcnt lgkmcnt(15)
    v_mfma_f32_16x16x32_bf16 v[132:135], v[168:171], a[228:231], v[132:135]
    buffer_load_dwordx4 v230, s[24:27], s86 offen offset:2048 lds
    ds_read_b32 v213, v18 offset:2048
    v_mfma_f32_16x16x32_bf16 v[108:111], v[172:175], a[244:247], v[108:111]
    ds_read_b32 v214, v19 offset:2048
    ds_read_b32 v215, v20 offset:2048
    v_mfma_f32_16x16x32_bf16 v[116:119], v[172:175], a[240:243], v[116:119]
    buffer_load_dwordx4 v231, s[24:27], s86 offen offset:3072 lds
    ds_read_b128 v[36:39], v23 offset:2048
    v_mfma_f32_16x16x32_bf16 v[124:127], v[172:175], a[228:231], v[124:127]
    s_add_u32 m0, m0, 4096
    ds_read_b128 v[52:55], v216 offset:2048
    v_mfma_f32_16x16x32_bf16 v[132:135], v[172:175], a[224:227], v[132:135]
    s_waitcnt lgkmcnt(15)
    v_and_b32 v88, 0xffff0000, v202
    v_mfma_f32_16x16x32_bf16 v[108:111], v[176:179], a[240:243], v[108:111]
    s_add_u32 s86, s86, 32768
    v_and_b32 v89, 0xffff0000, v203
    v_mfma_f32_16x16x32_bf16 v[116:119], v[176:179], a[236:239], v[116:119]
    v_lshlrev_b32 v90, 16, v202
    v_lshlrev_b32 v91, 16, v203
    v_mfma_f32_16x16x32_bf16 v[124:127], v[176:179], a[224:227], v[124:127]
    buffer_load_dwordx4 v228, s[24:27], s86 offen offset:0 lds
    v_fma_f32 v72, v88, v24, v40
    v_mfma_f32_16x16x32_bf16 v[108:111], v[180:183], a[236:239], v[108:111]
    buffer_load_dwordx4 v229, s[24:27], s86 offen offset:1024 lds
    v_fma_f32 v73, v89, v25, v41
    v_mfma_f32_16x16x32_bf16 v[116:119], v[180:183], a[232:235], v[116:119]
    v_fma_f32 v74, v90, v26, v42
    v_fma_f32 v75, v91, v27, v43
    v_mfma_f32_16x16x32_bf16 v[108:111], v[184:187], a[232:235], v[108:111]
    buffer_load_dwordx4 v230, s[24:27], s86 offen offset:2048 lds
    v_fma_f32 v72, v72, v7, v21
    v_mfma_f32_16x16x32_bf16 v[116:119], v[184:187], a[228:231], v[116:119]
    v_fma_f32 v73, v73, v7, v21
    v_fma_f32 v74, v74, v7, v21
    v_mfma_f32_16x16x32_bf16 v[108:111], v[188:191], a[228:231], v[108:111]
    buffer_load_dwordx4 v231, s[24:27], s86 offen offset:3072 lds
    v_fma_f32 v75, v75, v7, v21
    v_mfma_f32_16x16x32_bf16 v[116:119], v[188:191], a[224:227], v[116:119]
    v_and_b32 v92, 0xffff0000, v206
    v_and_b32 v93, 0xffff0000, v207
    v_mfma_f32_16x16x32_bf16 v[108:111], v[192:195], a[224:227], v[108:111]
    v_lshlrev_b32 v94, 16, v206
    v_lshlrev_b32 v95, 16, v207
    v_mfma_f32_16x16x32_bf16 v[104:107], v[168:171], a[216:219], v[104:107]
    s_waitcnt lgkmcnt(12)
    v_fma_f32 v76, v92, v28, v44
    v_fma_f32 v77, v93, v29, v45
    v_mfma_f32_16x16x32_bf16 v[112:115], v[168:171], a[212:215], v[112:115]
    v_fma_f32 v78, v94, v30, v46
    v_fma_f32 v79, v95, v31, v47
    v_mfma_f32_16x16x32_bf16 v[120:123], v[168:171], a[200:203], v[120:123]
    v_fma_f32 v76, v76, v7, v21
    v_fma_f32 v77, v77, v7, v21
    v_mfma_f32_16x16x32_bf16 v[128:131], v[168:171], a[196:199], v[128:131]
    v_fma_f32 v78, v78, v7, v21
    ds_write_b32 v218, v111 offset:1540
    ds_write_b32 v218, v119 offset:1284
    ds_write_b32 v218, v127 offset:516
    ds_write_b32 v218, v135 offset:260
    v_mfma_f32_16x16x32_bf16 v[104:107], v[172:175], a[212:215], v[104:107]
    v_fma_f32 v79, v79, v7, v21
    s_waitcnt lgkmcnt(13)
    v_and_b32 v96, 0xffff0000, v210
    v_mfma_f32_16x16x32_bf16 v[112:115], v[172:175], a[208:211], v[112:115]
    s_waitcnt lgkmcnt(12)
    v_and_b32 v97, 0xffff0000, v211
    v_lshlrev_b32 v98, 16, v210
    v_mfma_f32_16x16x32_bf16 v[120:123], v[172:175], a[196:199], v[120:123]
    v_lshlrev_b32 v99, 16, v211
    s_waitcnt lgkmcnt(0)
    s_barrier
    ds_read_b32 v56, v218 offset:1536
    ds_read_b32 v57, v218 offset:1280
    ds_read_b32 v58, v218 offset:512
    ds_read_b32 v59, v218 offset:256
    v_mfma_f32_16x16x32_bf16 v[128:131], v[172:175], a[192:195], v[128:131]
    v_fma_f32 v80, v96, v32, v48
    s_add_u32 s98, s94, s3
    s_lshl_b32 m0, s3, 13
    v_mfma_f32_16x16x32_bf16 v[104:107], v[176:179], a[208:211], v[104:107]
    v_fma_f32 v81, v97, v33, v49
    s_bitcmp1_b32 s98, 2
    s_cselect_b64 vcc, -1, 0
    s_add_u32 m0, m0, 98304
    v_mfma_f32_16x16x32_bf16 v[112:115], v[176:179], a[204:207], v[112:115]
    v_fma_f32 v82, v98, v34, v50
    s_and_b32 s98, s98, 3
    v_cndmask_b32 v245, v236, v237, vcc
    v_mfma_f32_16x16x32_bf16 v[120:123], v[176:179], a[192:195], v[120:123]
    v_fma_f32 v83, v99, v35, v51
    v_add_u32 v60, v245, v238
    v_add_u32 v61, v245, v239
    v_mfma_f32_16x16x32_bf16 v[104:107], v[180:183], a[204:207], v[104:107]
    v_fma_f32 v80, v80, v7, v21
    v_add_u32 v62, v245, v240
    v_add_u32 v63, v245, v241
    v_mfma_f32_16x16x32_bf16 v[112:115], v[180:183], a[200:203], v[112:115]
    v_fma_f32 v81, v81, v7, v21
    s_mul_i32 s86, s98, 229376
    s_lshl_b32 s98, s88, 8
    v_mfma_f32_16x16x32_bf16 v[104:107], v[184:187], a[200:203], v[104:107]
    v_fma_f32 v82, v82, v7, v21
    s_add_u32 s86, s86, s98
    s_lshl_b32 s98, 3, 6
    v_mfma_f32_16x16x32_bf16 v[112:115], v[184:187], a[196:199], v[112:115]
    v_fma_f32 v83, v83, v7, v21
    s_add_u32 s86, s86, s98
    buffer_load_dwordx4 v60, s[20:23], s86 offen offset:0 lds
    v_mfma_f32_16x16x32_bf16 v[104:107], v[188:191], a[196:199], v[104:107]
    v_and_b32 v100, 0xffff0000, v214
    buffer_load_dwordx4 v61, s[20:23], s86 offen offset:1024 lds
    buffer_load_dwordx4 v62, s[20:23], s86 offen offset:2048 lds
    v_mfma_f32_16x16x32_bf16 v[112:115], v[188:191], a[192:195], v[112:115]
    v_and_b32 v101, 0xffff0000, v215
    buffer_load_dwordx4 v63, s[20:23], s86 offen offset:3072 lds
    s_add_u32 m0, m0, 4096
    v_mfma_f32_16x16x32_bf16 v[104:107], v[192:195], a[192:195], v[104:107]
    v_lshlrev_b32 v102, 16, v214
    s_add_u32 s86, s86, 114688
    buffer_load_dwordx4 v60, s[20:23], s86 offen offset:0 lds
    v_lshlrev_b32 v103, 16, v215
    v_fma_f32 v84, v100, v36, v52
    v_fma_f32 v85, v101, v37, v53
    v_fma_f32 v86, v102, v38, v54
    v_fma_f32 v87, v103, v39, v55
    v_fma_f32 v84, v84, v7, v21
    v_fma_f32 v85, v85, v7, v21
    v_fma_f32 v86, v86, v7, v21
    v_fma_f32 v87, v87, v7, v21
    buffer_load_dwordx4 v61, s[20:23], s86 offen offset:1024 lds
    buffer_load_dwordx4 v62, s[20:23], s86 offen offset:2048 lds
    buffer_load_dwordx4 v63, s[20:23], s86 offen offset:3072 lds
    s_waitcnt lgkmcnt(3)
    v_fmac_f32 v88, v72, v56
    v_fmac_f32 v89, v73, v108
    v_fmac_f32 v90, v74, v109
    v_fmac_f32 v91, v75, v110
    s_waitcnt lgkmcnt(2)
    v_fmac_f32 v92, v76, v57
    v_fmac_f32 v93, v77, v116
    v_fmac_f32 v94, v78, v117
    v_fmac_f32 v95, v79, v118
    s_waitcnt lgkmcnt(1)
    v_fmac_f32 v96, v80, v58
    v_fmac_f32 v97, v81, v124
    v_fmac_f32 v98, v82, v125
    v_fmac_f32 v99, v83, v126
    s_waitcnt lgkmcnt(0)
    v_fmac_f32 v100, v84, v59
    v_fmac_f32 v101, v85, v132
    v_fmac_f32 v102, v86, v133
    v_fmac_f32 v103, v87, v134
    v_dot2_f32_bf16 v104, v200, v1, v104
    v_dot2_f32_bf16 v105, v201, v1, v105
    v_dot2_f32_bf16 v106, v200, v22, v106
    v_dot2_f32_bf16 v107, v201, v22, v107
    v_dot2_f32_bf16 v112, v204, v1, v112
    v_dot2_f32_bf16 v113, v205, v1, v113
    v_dot2_f32_bf16 v114, v204, v22, v114
    v_dot2_f32_bf16 v115, v205, v22, v115
    v_dot2_f32_bf16 v120, v208, v1, v120
    v_dot2_f32_bf16 v121, v209, v1, v121
    v_dot2_f32_bf16 v122, v208, v22, v122
    v_dot2_f32_bf16 v123, v209, v22, v123
    v_dot2_f32_bf16 v128, v212, v1, v128
    v_dot2_f32_bf16 v129, v213, v1, v129
    v_dot2_f32_bf16 v130, v212, v22, v130
    v_dot2_f32_bf16 v131, v213, v22, v131
    s_add_u32 s69, s96, 6291456
    s_add_u32 s68, s96, 4194304
    v_pk_fma_f32 v[88:89], v[72:73], v[104:105], v[88:89]
    v_pk_fma_f32 v[90:91], v[74:75], v[106:107], v[90:91]
    v_pk_mul_f32 v[24:25], v[88:89], v[216:217] op_sel:[0,1] op_sel_hi:[1,1]
    v_pk_mul_f32 v[26:27], v[90:91], v[216:217] op_sel:[0,1] op_sel_hi:[1,1]
    v_cvt_pk_bf16_f32 v144, v24, v25
    v_cvt_pk_bf16_f32 v145, v26, v27
    ds_write_b64 v219, v[144:145] offset:0
    v_pk_fma_f32 v[92:93], v[76:77], v[112:113], v[92:93]
    v_pk_fma_f32 v[94:95], v[78:79], v[114:115], v[94:95]
    v_pk_mul_f32 v[28:29], v[92:93], v[216:217] op_sel:[0,1] op_sel_hi:[1,1]
    v_pk_mul_f32 v[30:31], v[94:95], v[216:217] op_sel:[0,1] op_sel_hi:[1,1]
    v_cvt_pk_bf16_f32 v146, v28, v29
    v_cvt_pk_bf16_f32 v147, v30, v31
    ds_write_b64 v219, v[146:147] offset:512
    v_pk_fma_f32 v[96:97], v[80:81], v[120:121], v[96:97]
    v_pk_fma_f32 v[98:99], v[82:83], v[122:123], v[98:99]
    v_pk_mul_f32 v[32:33], v[96:97], v[216:217] op_sel:[0,1] op_sel_hi:[1,1]
    v_pk_mul_f32 v[34:35], v[98:99], v[216:217] op_sel:[0,1] op_sel_hi:[1,1]
    v_cvt_pk_bf16_f32 v148, v32, v33
    v_cvt_pk_bf16_f32 v149, v34, v35
    ds_write_b64 v219, v[148:149] offset:1024
    v_pk_fma_f32 v[100:101], v[84:85], v[128:129], v[100:101]
    v_pk_fma_f32 v[102:103], v[86:87], v[130:131], v[102:103]
    v_pk_mul_f32 v[36:37], v[100:101], v[216:217] op_sel:[0,1] op_sel_hi:[1,1]
    v_pk_mul_f32 v[38:39], v[102:103], v[216:217] op_sel:[0,1] op_sel_hi:[1,1]
    v_cvt_pk_bf16_f32 v150, v36, v37
    v_cvt_pk_bf16_f32 v151, v38, v39
    ds_write_b64 v219, v[150:151] offset:1536
    v_cvt_pk_bf16_f32 v136, v88, v89
    v_cvt_pk_bf16_f32 v137, v90, v91
    ds_write_b64 v219, v[136:137] offset:2048
    v_cvt_pk_bf16_f32 v138, v92, v93
    v_cvt_pk_bf16_f32 v139, v94, v95
    ds_write_b64 v219, v[138:139] offset:2560
    v_cvt_pk_bf16_f32 v140, v96, v97
    v_cvt_pk_bf16_f32 v141, v98, v99
    ds_write_b64 v219, v[140:141] offset:3072
    v_cvt_pk_bf16_f32 v142, v100, v101
    v_cvt_pk_bf16_f32 v143, v102, v103
    ds_write_b64 v219, v[142:143] offset:3584
    s_waitcnt lgkmcnt(4)
    ds_read_b128 v[152:155], v220 offset:0
    ds_read_b128 v[156:159], v220 offset:1024
    s_waitcnt lgkmcnt(2)
    ds_read_b128 v[160:163], v220 offset:2048
    ds_read_b128 v[164:167], v220 offset:3072
    s_waitcnt lgkmcnt(3)
    buffer_store_dwordx4 v[152:155], v221, s[36:39], s69 offen sc1
    s_waitcnt lgkmcnt(2)
    buffer_store_dwordx4 v[156:159], v222, s[36:39], s69 offen sc1
    s_waitcnt lgkmcnt(1)
    buffer_store_dwordx4 v[160:163], v221, s[36:39], s68 offen sc1
    s_waitcnt lgkmcnt(0)
    buffer_store_dwordx4 v[164:167], v222, s[36:39], s68 offen sc1
    s_waitcnt vmcnt(36)
    ds_read_b64_tr_b16 a[48:49], v242 offset:24576
    ds_read_b64_tr_b16 a[50:51], v242 offset:25088
    ds_read_b64_tr_b16 a[112:113], v243 offset:24576
    ds_read_b64_tr_b16 a[114:115], v243 offset:25088
    ds_read_b64_tr_b16 a[52:53], v242 offset:26624
    ds_read_b64_tr_b16 a[54:55], v242 offset:27136
    ds_read_b64_tr_b16 a[116:117], v243 offset:26624
    ds_read_b64_tr_b16 a[118:119], v243 offset:27136
    ds_read_b64_tr_b16 a[56:57], v242 offset:28672
    ds_read_b64_tr_b16 a[58:59], v242 offset:29184
    ds_read_b64_tr_b16 a[120:121], v243 offset:28672
    ds_read_b64_tr_b16 a[122:123], v243 offset:29184
    ds_read_b64_tr_b16 a[60:61], v242 offset:30720
    ds_read_b64_tr_b16 a[62:63], v242 offset:31232
    ds_read_b64_tr_b16 a[124:125], v243 offset:30720
    ds_read_b64_tr_b16 a[126:127], v243 offset:31232
    s_waitcnt lgkmcnt(0)
    s_add_u32 s98, s91, 3
    s_add_u32 m0, s89, 24576
    s_cmp_ge_u32 s98, 7
    s_cselect_b32 s86, 7, 0
    s_sub_u32 s98, s98, s86
    s_lshl_b32 s86, s98, 16
    s_add_u32 s86, s86, s90
    buffer_load_dwordx4 v228, s[24:27], s86 offen offset:0 lds
    buffer_load_dwordx4 v229, s[24:27], s86 offen offset:1024 lds
    buffer_load_dwordx4 v230, s[24:27], s86 offen offset:2048 lds
    buffer_load_dwordx4 v231, s[24:27], s86 offen offset:3072 lds
    s_add_u32 m0, m0, 4096
    s_add_u32 s86, s86, 32768
    buffer_load_dwordx4 v228, s[24:27], s86 offen offset:0 lds
    buffer_load_dwordx4 v229, s[24:27], s86 offen offset:1024 lds
    buffer_load_dwordx4 v230, s[24:27], s86 offen offset:2048 lds
    buffer_load_dwordx4 v231, s[24:27], s86 offen offset:3072 lds
    s_branch L_convdone
L_conv3:
    ds_read_b64_tr_b16 v[136:137], v16 offset:0
    ds_read_b64_tr_b16 v[138:139], v16 offset:16
    ds_read_b128 a[152:155], v8 offset:12288
    ds_read_b128 a[184:187], v9 offset:12288
    ds_read_b128 a[148:151], v8 offset:10240
    ds_read_b128 a[180:183], v9 offset:10240
    ds_read_b128 a[136:139], v8 offset:4096
    ds_read_b128 a[168:171], v9 offset:4096
    ds_read_b128 a[132:135], v8 offset:2048
    ds_read_b128 a[164:167], v9 offset:2048
    ds_read_b64_tr_b16 v[140:141], v16 offset:512
    ds_read_b64_tr_b16 v[142:143], v16 offset:528
    ds_read_b128 a[144:147], v8 offset:8192
    ds_read_b128 a[176:179], v9 offset:8192
    ds_read_b128 a[128:131], v8 offset:0
    ds_read_b128 a[160:163], v9 offset:0
    ds_read_b64_tr_b16 v[144:145], v16 offset:1024
    ds_read_b64_tr_b16 v[146:147], v16 offset:1040
    s_waitcnt lgkmcnt(15)
    v_mfma_f32_16x16x32_bf16 v[104:107], v[136:139], a[152:155], 0
    ds_read_b128 a[140:143], v8 offset:6144
    ds_read_b128 a[172:175], v9 offset:6144
    s_waitcnt lgkmcnt(15)
    v_mfma_f32_16x16x32_bf16 v[108:111], v[136:139], a[184:187], 0
    ds_read_b64_tr_b16 v[148:149], v16 offset:1536
    ds_read_b64_tr_b16 v[150:151], v16 offset:1552
    v_mfma_f32_16x16x32_bf16 v[112:115], v[136:139], a[148:151], 0
    ds_read_b64_tr_b16 v[152:153], v16 offset:2048
    ds_read_b64_tr_b16 v[154:155], v16 offset:2064
    s_waitcnt lgkmcnt(15)
    v_mfma_f32_16x16x32_bf16 v[116:119], v[136:139], a[180:183], 0
    ds_read_b64_tr_b16 v[156:157], v16 offset:2560
    buffer_load_dword v21, v21, s[36:39], s63 offen sc1
    v_mfma_f32_16x16x32_bf16 v[120:123], v[136:139], a[136:139], 0
    ds_read_b64_tr_b16 v[158:159], v16 offset:2576
    v_lshlrev_b32 v44, 4, v0
    v_mfma_f32_16x16x32_bf16 v[124:127], v[136:139], a[168:171], 0
    ds_read_b64_tr_b16 v[160:161], v16 offset:3072
    s_mov_b32 s54, 16848896
    v_mfma_f32_16x16x32_bf16 v[128:131], v[136:139], a[132:135], 0
    ds_read_b64_tr_b16 v[162:163], v16 offset:3088
    s_mov_b32 s55, 16861184
    s_waitcnt lgkmcnt(15)
    v_mfma_f32_16x16x32_bf16 v[132:135], v[136:139], a[164:167], 0
    ds_read_b64_tr_b16 v[168:169], v16 offset:128
    s_mov_b32 s56, 16873472
    v_mfma_f32_16x16x32_bf16 v[104:107], v[140:143], a[148:151], v[104:107]
    ds_read_b64_tr_b16 v[170:171], v16 offset:144
    s_mov_b32 s57, 16885760
    v_mfma_f32_16x16x32_bf16 v[108:111], v[140:143], a[180:183], v[108:111]
    ds_read_b128 a[216:219], v10 offset:12288
    buffer_load_dwordx4 v[24:27], v44, s[36:39], s54 offen sc1
    v_mfma_f32_16x16x32_bf16 v[112:115], v[140:143], a[144:147], v[112:115]
    ds_read_b128 a[248:251], v11 offset:12288
    buffer_load_dwordx4 v[28:31], v44, s[36:39], s55 offen sc1
    s_waitcnt lgkmcnt(15)
    v_mfma_f32_16x16x32_bf16 v[116:119], v[140:143], a[176:179], v[116:119]
    ds_read_b128 a[212:215], v10 offset:10240
    buffer_load_dwordx4 v[32:35], v44, s[36:39], s56 offen sc1
    v_mfma_f32_16x16x32_bf16 v[120:123], v[140:143], a[132:135], v[120:123]
    ds_read_b128 a[244:247], v11 offset:10240
    buffer_load_dwordx4 v[36:39], v44, s[36:39], s57 offen sc1
    v_mfma_f32_16x16x32_bf16 v[124:127], v[140:143], a[164:167], v[124:127]
    ds_read_b128 a[200:203], v10 offset:4096
    v_lshlrev_b32 v45, 2, v2
    v_mfma_f32_16x16x32_bf16 v[128:131], v[140:143], a[128:131], v[128:131]
    ds_read_b128 a[232:235], v11 offset:4096
    s_lshl_b32 s58, s93, 8
    v_mfma_f32_16x16x32_bf16 v[132:135], v[140:143], a[160:163], v[132:135]
    ds_read_b128 a[196:199], v10 offset:2048
    s_add_u32 s54, s58, 16852992
    s_waitcnt lgkmcnt(15)
    v_mfma_f32_16x16x32_bf16 v[104:107], v[144:147], a[144:147], v[104:107]
    ds_read_b128 a[228:231], v11 offset:2048
    s_add_u32 s55, s58, 16865280
    v_mfma_f32_16x16x32_bf16 v[108:111], v[144:147], a[176:179], v[108:111]
    ds_read_b64_tr_b16 v[172:173], v16 offset:640
    s_add_u32 s56, s58, 16877568
    v_mfma_f32_16x16x32_bf16 v[112:115], v[144:147], a[140:143], v[112:115]
    ds_read_b64_tr_b16 v[174:175], v16 offset:656
    s_add_u32 s57, s58, 16889856
    v_mfma_f32_16x16x32_bf16 v[116:119], v[144:147], a[172:175], v[116:119]
    ds_read_b128 a[208:211], v10 offset:8192
    buffer_load_dword v40, v45, s[36:39], s54 offen sc1
    v_mfma_f32_16x16x32_bf16 v[120:123], v[144:147], a[128:131], v[120:123]
    ds_read_b128 a[240:243], v11 offset:8192
    buffer_load_dword v41, v45, s[36:39], s55 offen sc1
    v_mfma_f32_16x16x32_bf16 v[124:127], v[144:147], a[160:163], v[124:127]
    ds_read_b128 a[192:195], v10 offset:0
    buffer_load_dword v42, v45, s[36:39], s56 offen sc1
    v_mfma_f32_16x16x32_bf16 v[104:107], v[148:151], a[140:143], v[104:107]
    ds_read_b128 a[224:227], v11 offset:0
    buffer_load_dword v43, v45, s[36:39], s57 offen sc1
    v_mfma_f32_16x16x32_bf16 v[108:111], v[148:151], a[172:175], v[108:111]
    ds_read_b64_tr_b16 v[176:177], v16 offset:1152
    v_mfma_f32_16x16x32_bf16 v[112:115], v[148:151], a[136:139], v[112:115]
    ds_read_b64_tr_b16 v[178:179], v16 offset:1168
    v_mfma_f32_16x16x32_bf16 v[116:119], v[148:151], a[168:171], v[116:119]
    ds_read_b128 a[204:207], v10 offset:6144
    s_waitcnt lgkmcnt(15)
    v_mfma_f32_16x16x32_bf16 v[104:107], v[152:155], a[136:139], v[104:107]
    ds_read_b128 a[236:239], v11 offset:6144
    v_mfma_f32_16x16x32_bf16 v[108:111], v[152:155], a[168:171], v[108:111]
    ds_read_b64_tr_b16 v[180:181], v16 offset:1664
    v_mfma_f32_16x16x32_bf16 v[112:115], v[152:155], a[132:135], v[112:115]
    ds_read_b64_tr_b16 v[182:183], v16 offset:1680
    v_mfma_f32_16x16x32_bf16 v[116:119], v[152:155], a[164:167], v[116:119]
    ds_read_b64_tr_b16 v[184:185], v16 offset:2176
    v_mfma_f32_16x16x32_bf16 v[104:107], v[156:159], a[132:135], v[104:107]
    ds_read_b64_tr_b16 v[186:187], v16 offset:2192
    v_mfma_f32_16x16x32_bf16 v[108:111], v[156:159], a[164:167], v[108:111]
    ds_read_b64_tr_b16 v[188:189], v16 offset:2688
    v_mfma_f32_16x16x32_bf16 v[112:115], v[156:159], a[128:131], v[112:115]
    ds_read_b64_tr_b16 v[190:191], v16 offset:2704
    v_mfma_f32_16x16x32_bf16 v[116:119], v[156:159], a[160:163], v[116:119]
    ds_read_b64_tr_b16 v[192:193], v16 offset:3200
    v_mfma_f32_16x16x32_bf16 v[104:107], v[160:163], a[128:131], v[104:107]
    ds_read_b64_tr_b16 v[194:195], v16 offset:3216
    v_mfma_f32_16x16x32_bf16 v[108:111], v[160:163], a[160:163], v[108:111]
    v_mfma_f32_16x16x32_bf16 v[104:107], v[168:171], a[216:219], v[104:107]
    ds_read_b64_tr_b16 v[136:137], v16 offset:256
    s_waitcnt vmcnt(8)
    v_add_f32_dpp v21, v21, v21 quad_perm:[1,0,3,2] row_mask:0xf bank_mask:0xf
    v_mfma_f32_16x16x32_bf16 v[108:111], v[168:171], a[248:251], v[108:111]
    ds_read_b64_tr_b16 v[138:139], v16 offset:272
    v_lshlrev_b32 v1, 16, v22
    s_waitcnt lgkmcnt(15)
    v_mfma_f32_16x16x32_bf16 v[112:115], v[168:171], a[212:215], v[112:115]
    ds_read_b128 a[152:155], v12 offset:12288
    v_add_f32_dpp v21, v21, v21 quad_perm:[2,3,0,1] row_mask:0xf bank_mask:0xf
    v_mfma_f32_16x16x32_bf16 v[116:119], v[168:171], a[244:247], v[116:119]
    ds_read_b128 a[184:187], v13 offset:12288
    v_cvt_pk_bf16_f32 v21, v21, v21
    v_mfma_f32_16x16x32_bf16 v[120:123], v[168:171], a[200:203], v[120:123]
    ds_read_b128 a[148:151], v12 offset:10240
    v_lshlrev_b32 v21, 16, v21
    v_mfma_f32_16x16x32_bf16 v[124:127], v[168:171], a[232:235], v[124:127]
    ds_read_b128 a[180:183], v13 offset:10240
    v_add_f32 v5, 1.0, v21
    v_mfma_f32_16x16x32_bf16 v[128:131], v[168:171], a[196:199], v[128:131]
    ds_read_b128 a[136:139], v12 offset:4096
    v_cvt_pk_bf16_f32 v5, v5, v5
    v_mfma_f32_16x16x32_bf16 v[132:135], v[168:171], a[228:231], v[132:135]
    ds_read_b128 a[168:171], v13 offset:4096
    v_lshlrev_b32 v5, 16, v5
    v_mfma_f32_16x16x32_bf16 v[104:107], v[172:175], a[212:215], v[104:107]
    ds_read_b128 a[132:135], v12 offset:2048
    v_readlane_b32 s70, v21, 0
    v_mfma_f32_16x16x32_bf16 v[108:111], v[172:175], a[244:247], v[108:111]
    ds_read_b128 a[164:167], v13 offset:2048
    v_readlane_b32 s72, v21, 8
    v_mfma_f32_16x16x32_bf16 v[112:115], v[172:175], a[208:211], v[112:115]
    ds_read_b64_tr_b16 v[140:141], v16 offset:768
    v_readlane_b32 s71, v5, 4
    v_mfma_f32_16x16x32_bf16 v[116:119], v[172:175], a[240:243], v[116:119]
    ds_read_b64_tr_b16 v[142:143], v16 offset:784
    v_readlane_b32 s73, v5, 12
    v_mfma_f32_16x16x32_bf16 v[120:123], v[172:175], a[196:199], v[120:123]
    ds_read_b128 a[144:147], v12 offset:8192
    v_mov_b32 v5, s72
    v_mfma_f32_16x16x32_bf16 v[124:127], v[172:175], a[228:231], v[124:127]
    ds_read_b128 a[176:179], v13 offset:8192
    v_mul_f32 v7, s71, v5
    v_mfma_f32_16x16x32_bf16 v[128:131], v[172:175], a[192:195], v[128:131]
    ds_read_b128 a[128:131], v12 offset:0
    v_mul_f32 v21, s70, v5
    s_waitcnt lgkmcnt(15)
    v_mfma_f32_16x16x32_bf16 v[132:135], v[172:175], a[224:227], v[132:135]
    ds_read_b128 a[160:163], v13 offset:0
    v_mov_b32 v217, s73
    v_mfma_f32_16x16x32_bf16 v[104:107], v[176:179], a[208:211], v[104:107]
    ds_read_b64_tr_b16 v[144:145], v16 offset:1280
    s_lshr_b32 s59, s3, 1
    v_mfma_f32_16x16x32_bf16 v[108:111], v[176:179], a[240:243], v[108:111]
    ds_read_b64_tr_b16 v[146:147], v16 offset:1296
    v_cvt_f32_u32 v46, s59
    v_mfma_f32_16x16x32_bf16 v[112:115], v[176:179], a[204:207], v[112:115]
    ds_read_b128 a[140:143], v12 offset:6144
    s_xor_b32 s59, s59, 1
    v_mfma_f32_16x16x32_bf16 v[116:119], v[176:179], a[236:239], v[116:119]
    ds_read_b128 a[172:175], v13 offset:6144
    s_lshl_b32 s59, s59, 10
    v_mfma_f32_16x16x32_bf16 v[120:123], v[176:179], a[192:195], v[120:123]
    ds_read_b64_tr_b16 v[148:149], v16 offset:1792
    s_add_u32 s59, s59, 147968
    v_mfma_f32_16x16x32_bf16 v[124:127], v[176:179], a[224:227], v[124:127]
    ds_read_b64_tr_b16 v[150:151], v16 offset:1808
    s_lshl_b32 s58, s94, 7
    v_mfma_f32_16x16x32_bf16 v[104:107], v[180:183], a[204:207], v[104:107]
    ds_read_b64_tr_b16 v[152:153], v16 offset:2304
    v_lshrrev_b32 v44, 1, v44
    v_mfma_f32_16x16x32_bf16 v[108:111], v[180:183], a[236:239], v[108:111]
    ds_read_b64_tr_b16 v[154:155], v16 offset:2320
    v_subrev_u32 v44, s58, v44
    v_mfma_f32_16x16x32_bf16 v[112:115], v[180:183], a[200:203], v[112:115]
    ds_read_b64_tr_b16 v[156:157], v16 offset:2816
    v_and_b32 v44, 0x3ff, v44
    v_mfma_f32_16x16x32_bf16 v[116:119], v[180:183], a[232:235], v[116:119]
    ds_read_b64_tr_b16 v[158:159], v16 offset:2832
    v_add_u32 v44, s59, v44
    v_mfma_f32_16x16x32_bf16 v[104:107], v[184:187], a[200:203], v[104:107]
    ds_read_b64_tr_b16 v[160:161], v16 offset:3328
    s_waitcnt vmcnt(6)
    v_add_f32 v24, v24, v28
    v_mfma_f32_16x16x32_bf16 v[108:111], v[184:187], a[232:235], v[108:111]
    ds_read_b64_tr_b16 v[162:163], v16 offset:3344
    s_waitcnt vmcnt(4)
    v_add_f32 v32, v32, v36
    v_mfma_f32_16x16x32_bf16 v[112:115], v[184:187], a[196:199], v[112:115]
    v_add_f32 v25, v25, v29
    v_mfma_f32_16x16x32_bf16 v[116:119], v[184:187], a[228:231], v[116:119]
    v_add_f32 v33, v33, v37
    v_mfma_f32_16x16x32_bf16 v[104:107], v[188:191], a[196:199], v[104:107]
    v_add_f32 v26, v26, v30
    v_mfma_f32_16x16x32_bf16 v[108:111], v[188:191], a[228:231], v[108:111]
    v_add_f32 v34, v34, v38
    v_mfma_f32_16x16x32_bf16 v[112:115], v[188:191], a[192:195], v[112:115]
    v_add_f32 v27, v27, v31
    v_mfma_f32_16x16x32_bf16 v[116:119], v[188:191], a[224:227], v[116:119]
    v_add_f32 v35, v35, v39
    v_mfma_f32_16x16x32_bf16 v[104:107], v[192:195], a[192:195], v[104:107]
    v_add_f32 v24, v24, v32
    v_mfma_f32_16x16x32_bf16 v[108:111], v[192:195], a[224:227], v[108:111]
    v_add_f32 v25, v25, v33
    v_add_f32 v26, v26, v34
    v_add_f32 v27, v27, v35
    s_waitcnt vmcnt(2)
    v_add_f32 v40, v40, v41
    s_waitcnt vmcnt(0)
    v_add_f32 v42, v42, v43
    v_cvt_pk_bf16_f32 v28, v24, v25
    v_cvt_pk_bf16_f32 v29, v26, v27
    v_add_f32 v40, v40, v42
    v_lshlrev_b32 v24, 16, v28
    v_and_b32 v25, 0xffff0000, v28
    v_lshlrev_b32 v26, 16, v29
    v_and_b32 v27, 0xffff0000, v29
    v_cvt_pk_bf16_f32 v40, v40, v40
    v_add_f32 v24, v46, v24
    v_add_f32 v25, v46, v25
    v_add_f32 v26, v46, v26
    v_add_f32 v27, v46, v27
    v_lshlrev_b32 v40, 16, v40
    v_cvt_pk_bf16_f32 v28, v24, v25
    v_cvt_pk_bf16_f32 v29, v26, v27
    v_mul_f32 v40, 0xbf317218, v40
    ds_write_b64 v44, v[28:29]
    v_add_u32 v45, 152960, v45
    ds_write_b32 v45, v40
    v_mov_b32 v41, 0
    v_and_b32 v42, 60, v45
    v_add_u32 v42, 150016, v42
    ds_write_b32 v42, v41
    s_waitcnt vmcnt(10)
    s_barrier
    s_waitcnt lgkmcnt(15)
    v_mfma_f32_16x16x32_bf16 v[104:107], v[136:139], a[152:155], v[104:107]
    ds_read_b64_tr_b16 v[168:169], v16 offset:384
    ds_read_b32 v200, v17 offset:12288
    v_mfma_f32_16x16x32_bf16 v[108:111], v[136:139], a[184:187], v[108:111]
    ds_read_b64_tr_b16 v[170:171], v16 offset:400
    ds_read_b32 v201, v18 offset:12288
    v_mfma_f32_16x16x32_bf16 v[112:115], v[136:139], a[148:151], v[112:115]
    ds_read_b128 a[248:251], v15 offset:12288
    ds_read_b32 v202, v19 offset:12288
    v_mfma_f32_16x16x32_bf16 v[116:119], v[136:139], a[180:183], v[116:119]
    ds_read_b128 a[244:247], v15 offset:10240
    ds_read_b32 v203, v20 offset:12288
    v_mfma_f32_16x16x32_bf16 v[120:123], v[136:139], a[136:139], v[120:123]
    ds_read_b128 a[232:235], v15 offset:4096
    ds_read_b128 v[24:27], v23 offset:12288
    v_mfma_f32_16x16x32_bf16 v[124:127], v[136:139], a[168:171], v[124:127]
    ds_read_b128 a[228:231], v15 offset:2048
    ds_read_b128 v[40:43], v216 offset:12288
    v_mfma_f32_16x16x32_bf16 v[128:131], v[136:139], a[132:135], v[128:131]
    ds_read_b64_tr_b16 v[172:173], v16 offset:896
    ds_read_b32 v204, v17 offset:10240
    v_mfma_f32_16x16x32_bf16 v[132:135], v[136:139], a[164:167], v[132:135]
    ds_read_b64_tr_b16 v[174:175], v16 offset:912
    ds_read_b32 v205, v18 offset:10240
    v_mfma_f32_16x16x32_bf16 v[104:107], v[140:143], a[148:151], v[104:107]
    ds_read_b128 a[240:243], v15 offset:8192
    ds_read_b32 v206, v19 offset:10240
    v_mfma_f32_16x16x32_bf16 v[108:111], v[140:143], a[180:183], v[108:111]
    ds_read_b128 a[224:227], v15 offset:0
    ds_read_b32 v207, v20 offset:10240
    v_mfma_f32_16x16x32_bf16 v[112:115], v[140:143], a[144:147], v[112:115]
    ds_read_b64_tr_b16 v[176:177], v16 offset:1408
    ds_read_b128 v[28:31], v23 offset:10240
    v_mfma_f32_16x16x32_bf16 v[116:119], v[140:143], a[176:179], v[116:119]
    ds_read_b64_tr_b16 v[178:179], v16 offset:1424
    ds_read_b128 v[44:47], v216 offset:10240
    v_mfma_f32_16x16x32_bf16 v[120:123], v[140:143], a[132:135], v[120:123]
    ds_read_b128 a[236:239], v15 offset:6144
    ds_read_b32 v208, v17 offset:4096
    v_mfma_f32_16x16x32_bf16 v[124:127], v[140:143], a[164:167], v[124:127]
    ds_read_b64_tr_b16 v[180:181], v16 offset:1920
    ds_read_b32 v209, v18 offset:4096
    v_mfma_f32_16x16x32_bf16 v[128:131], v[140:143], a[128:131], v[128:131]
    ds_read_b64_tr_b16 v[182:183], v16 offset:1936
    ds_read_b32 v210, v19 offset:4096
    v_mfma_f32_16x16x32_bf16 v[132:135], v[140:143], a[160:163], v[132:135]
    ds_read_b64_tr_b16 v[184:185], v16 offset:2432
    ds_read_b32 v211, v20 offset:4096
    s_waitcnt lgkmcnt(15)
    v_mfma_f32_16x16x32_bf16 v[104:107], v[144:147], a[144:147], v[104:107]
    ds_read_b64_tr_b16 v[186:187], v16 offset:2448
    ds_read_b128 v[32:35], v23 offset:4096
    v_mfma_f32_16x16x32_bf16 v[108:111], v[144:147], a[176:179], v[108:111]
    ds_read_b64_tr_b16 v[188:189], v16 offset:2944
    ds_read_b128 v[48:51], v216 offset:4096
    v_mfma_f32_16x16x32_bf16 v[112:115], v[144:147], a[140:143], v[112:115]
    ds_read_b64_tr_b16 v[190:191], v16 offset:2960
    ds_read_b32 v212, v17 offset:2048
    v_mfma_f32_16x16x32_bf16 v[116:119], v[144:147], a[172:175], v[116:119]
    ds_read_b64_tr_b16 v[192:193], v16 offset:3456
    ds_read_b32 v213, v18 offset:2048
    v_mfma_f32_16x16x32_bf16 v[120:123], v[144:147], a[128:131], v[120:123]
    ds_read_b64_tr_b16 v[194:195], v16 offset:3472
    ds_read_b32 v214, v19 offset:2048
    v_mfma_f32_16x16x32_bf16 v[124:127], v[144:147], a[160:163], v[124:127]
    ds_read_b128 a[216:219], v14 offset:12288
    ds_read_b32 v215, v20 offset:2048
    v_mfma_f32_16x16x32_bf16 v[104:107], v[148:151], a[140:143], v[104:107]
    ds_read_b128 a[212:215], v14 offset:10240
    ds_read_b128 v[36:39], v23 offset:2048
    v_mfma_f32_16x16x32_bf16 v[108:111], v[148:151], a[172:175], v[108:111]
    ds_read_b128 a[200:203], v14 offset:4096
    ds_read_b128 v[52:55], v216 offset:2048
    v_mfma_f32_16x16x32_bf16 v[112:115], v[148:151], a[136:139], v[112:115]
    ds_read_b128 a[196:199], v14 offset:2048
    s_waitcnt lgkmcnt(15)
    v_mfma_f32_16x16x32_bf16 v[116:119], v[148:151], a[168:171], v[116:119]
    ds_read_b128 a[208:211], v14 offset:8192
    v_and_b32 v88, 0xffff0000, v202
    v_mfma_f32_16x16x32_bf16 v[104:107], v[152:155], a[136:139], v[104:107]
    ds_read_b128 a[192:195], v14 offset:0
    v_and_b32 v89, 0xffff0000, v203
    v_mfma_f32_16x16x32_bf16 v[108:111], v[152:155], a[168:171], v[108:111]
    ds_read_b128 a[204:207], v14 offset:6144
    v_lshlrev_b32 v90, 16, v202
    v_mfma_f32_16x16x32_bf16 v[112:115], v[152:155], a[132:135], v[112:115]
    v_lshlrev_b32 v91, 16, v203
    v_mfma_f32_16x16x32_bf16 v[116:119], v[152:155], a[164:167], v[116:119]
    v_fma_f32 v72, v88, v24, v40
    v_mfma_f32_16x16x32_bf16 v[104:107], v[156:159], a[132:135], v[104:107]
    v_fma_f32 v73, v89, v25, v41
    v_mfma_f32_16x16x32_bf16 v[108:111], v[156:159], a[164:167], v[108:111]
    v_fma_f32 v74, v90, v26, v42
    v_mfma_f32_16x16x32_bf16 v[112:115], v[156:159], a[128:131], v[112:115]
    v_fma_f32 v75, v91, v27, v43
    v_mfma_f32_16x16x32_bf16 v[116:119], v[156:159], a[160:163], v[116:119]
    v_fma_f32 v72, v72, v7, v21
    v_mfma_f32_16x16x32_bf16 v[104:107], v[160:163], a[128:131], v[104:107]
    v_fma_f32 v73, v73, v7, v21
    v_mfma_f32_16x16x32_bf16 v[108:111], v[160:163], a[160:163], v[108:111]
    v_fma_f32 v74, v74, v7, v21
    v_mfma_f32_16x16x32_bf16 v[108:111], v[168:171], a[248:251], v[108:111]
    v_fma_f32 v75, v75, v7, v21
    v_and_b32 v92, 0xffff0000, v206
    v_mfma_f32_16x16x32_bf16 v[116:119], v[168:171], a[244:247], v[116:119]
    v_and_b32 v93, 0xffff0000, v207
    v_lshlrev_b32 v94, 16, v206
    v_mfma_f32_16x16x32_bf16 v[124:127], v[168:171], a[232:235], v[124:127]
    v_lshlrev_b32 v95, 16, v207
    v_fma_f32 v76, v92, v28, v44
    v_mfma_f32_16x16x32_bf16 v[132:135], v[168:171], a[228:231], v[132:135]
    v_fma_f32 v77, v93, v29, v45
    v_fma_f32 v78, v94, v30, v46
    v_mfma_f32_16x16x32_bf16 v[108:111], v[172:175], a[244:247], v[108:111]
    v_fma_f32 v79, v95, v31, v47
    v_fma_f32 v76, v76, v7, v21
    v_mfma_f32_16x16x32_bf16 v[116:119], v[172:175], a[240:243], v[116:119]
    v_fma_f32 v77, v77, v7, v21
    v_fma_f32 v78, v78, v7, v21
    v_mfma_f32_16x16x32_bf16 v[124:127], v[172:175], a[228:231], v[124:127]
    v_fma_f32 v79, v79, v7, v21
    v_and_b32 v96, 0xffff0000, v210
    v_mfma_f32_16x16x32_bf16 v[132:135], v[172:175], a[224:227], v[132:135]
    v_and_b32 v97, 0xffff0000, v211
    v_lshlrev_b32 v98, 16, v210
    v_mfma_f32_16x16x32_bf16 v[108:111], v[176:179], a[240:243], v[108:111]
    v_lshlrev_b32 v99, 16, v211
    s_waitcnt lgkmcnt(15)
    v_fma_f32 v80, v96, v32, v48
    v_mfma_f32_16x16x32_bf16 v[116:119], v[176:179], a[236:239], v[116:119]
    v_fma_f32 v81, v97, v33, v49
    v_fma_f32 v82, v98, v34, v50
    v_mfma_f32_16x16x32_bf16 v[124:127], v[176:179], a[224:227], v[124:127]
    v_fma_f32 v83, v99, v35, v51
    v_fma_f32 v80, v80, v7, v21
    v_mfma_f32_16x16x32_bf16 v[108:111], v[180:183], a[236:239], v[108:111]
    v_fma_f32 v81, v81, v7, v21
    v_fma_f32 v82, v82, v7, v21
    v_mfma_f32_16x16x32_bf16 v[116:119], v[180:183], a[232:235], v[116:119]
    v_fma_f32 v83, v83, v7, v21
    s_waitcnt lgkmcnt(10)
    v_and_b32 v100, 0xffff0000, v214
    v_mfma_f32_16x16x32_bf16 v[108:111], v[184:187], a[232:235], v[108:111]
    s_waitcnt lgkmcnt(8)
    v_and_b32 v101, 0xffff0000, v215
    v_lshlrev_b32 v102, 16, v214
    v_mfma_f32_16x16x32_bf16 v[116:119], v[184:187], a[228:231], v[116:119]
    v_lshlrev_b32 v103, 16, v215
    s_waitcnt lgkmcnt(4)
    v_fma_f32 v84, v100, v36, v52
    v_mfma_f32_16x16x32_bf16 v[108:111], v[188:191], a[228:231], v[108:111]
    v_fma_f32 v85, v101, v37, v53
    v_fma_f32 v86, v102, v38, v54
    v_mfma_f32_16x16x32_bf16 v[116:119], v[188:191], a[224:227], v[116:119]
    v_fma_f32 v87, v103, v39, v55
    v_fma_f32 v84, v84, v7, v21
    v_mfma_f32_16x16x32_bf16 v[108:111], v[192:195], a[224:227], v[108:111]
    v_fma_f32 v85, v85, v7, v21
    v_fma_f32 v86, v86, v7, v21
    v_mfma_f32_16x16x32_bf16 v[104:107], v[168:171], a[216:219], v[104:107]
    v_fma_f32 v87, v87, v7, v21
    v_mfma_f32_16x16x32_bf16 v[112:115], v[168:171], a[212:215], v[112:115]
    v_mfma_f32_16x16x32_bf16 v[120:123], v[168:171], a[200:203], v[120:123]
    s_waitcnt lgkmcnt(3)
    v_mfma_f32_16x16x32_bf16 v[128:131], v[168:171], a[196:199], v[128:131]
    ds_write_b32 v218, v111 offset:1540
    ds_write_b32 v218, v119 offset:1284
    ds_write_b32 v218, v127 offset:516
    ds_write_b32 v218, v135 offset:260
    v_mfma_f32_16x16x32_bf16 v[104:107], v[172:175], a[212:215], v[104:107]
    s_waitcnt lgkmcnt(6)
    v_mfma_f32_16x16x32_bf16 v[112:115], v[172:175], a[208:211], v[112:115]
    v_mfma_f32_16x16x32_bf16 v[120:123], v[172:175], a[196:199], v[120:123]
    s_waitcnt lgkmcnt(0)
    s_barrier
    ds_read_b32 v56, v218 offset:1536
    ds_read_b32 v57, v218 offset:1280
    ds_read_b32 v58, v218 offset:512
    ds_read_b32 v59, v218 offset:256
    v_mfma_f32_16x16x32_bf16 v[128:131], v[172:175], a[192:195], v[128:131]
    s_add_u32 s98, s94, s3
    s_lshl_b32 m0, s3, 13
    v_mfma_f32_16x16x32_bf16 v[104:107], v[176:179], a[208:211], v[104:107]
    s_bitcmp1_b32 s98, 2
    s_cselect_b64 vcc, -1, 0
    s_add_u32 m0, m0, 98304
    v_mfma_f32_16x16x32_bf16 v[112:115], v[176:179], a[204:207], v[112:115]
    s_and_b32 s98, s98, 3
    v_cndmask_b32 v245, v236, v237, vcc
    v_mfma_f32_16x16x32_bf16 v[120:123], v[176:179], a[192:195], v[120:123]
    v_add_u32 v60, v245, v238
    v_add_u32 v61, v245, v239
    v_mfma_f32_16x16x32_bf16 v[104:107], v[180:183], a[204:207], v[104:107]
    v_add_u32 v62, v245, v240
    v_add_u32 v63, v245, v241
    v_mfma_f32_16x16x32_bf16 v[112:115], v[180:183], a[200:203], v[112:115]
    s_mul_i32 s86, s98, 229376
    s_lshl_b32 s98, s88, 8
    v_mfma_f32_16x16x32_bf16 v[104:107], v[184:187], a[200:203], v[104:107]
    s_add_u32 s86, s86, s98
    s_lshl_b32 s98, 3, 6
    v_mfma_f32_16x16x32_bf16 v[112:115], v[184:187], a[196:199], v[112:115]
    s_add_u32 s86, s86, s98
    buffer_load_dwordx4 v60, s[20:23], s86 offen offset:0 lds
    v_mfma_f32_16x16x32_bf16 v[104:107], v[188:191], a[196:199], v[104:107]
    buffer_load_dwordx4 v61, s[20:23], s86 offen offset:1024 lds
    buffer_load_dwordx4 v62, s[20:23], s86 offen offset:2048 lds
    v_mfma_f32_16x16x32_bf16 v[112:115], v[188:191], a[192:195], v[112:115]
    buffer_load_dwordx4 v63, s[20:23], s86 offen offset:3072 lds
    s_add_u32 m0, m0, 4096
    v_mfma_f32_16x16x32_bf16 v[104:107], v[192:195], a[192:195], v[104:107]
    s_add_u32 s86, s86, 114688
    buffer_load_dwordx4 v60, s[20:23], s86 offen offset:0 lds
    buffer_load_dwordx4 v61, s[20:23], s86 offen offset:1024 lds
    buffer_load_dwordx4 v62, s[20:23], s86 offen offset:2048 lds
    buffer_load_dwordx4 v63, s[20:23], s86 offen offset:3072 lds
    s_waitcnt lgkmcnt(3)
    v_fmac_f32 v88, v72, v56
    v_fmac_f32 v89, v73, v108
    v_fmac_f32 v90, v74, v109
    v_fmac_f32 v91, v75, v110
    s_waitcnt lgkmcnt(2)
    v_fmac_f32 v92, v76, v57
    v_fmac_f32 v93, v77, v116
    v_fmac_f32 v94, v78, v117
    v_fmac_f32 v95, v79, v118
    s_waitcnt lgkmcnt(1)
    v_fmac_f32 v96, v80, v58
    v_fmac_f32 v97, v81, v124
    v_fmac_f32 v98, v82, v125
    v_fmac_f32 v99, v83, v126
    s_waitcnt lgkmcnt(0)
    v_fmac_f32 v100, v84, v59
    v_fmac_f32 v101, v85, v132
    v_fmac_f32 v102, v86, v133
    v_fmac_f32 v103, v87, v134
    v_dot2_f32_bf16 v104, v200, v1, v104
    v_dot2_f32_bf16 v105, v201, v1, v105
    v_dot2_f32_bf16 v106, v200, v22, v106
    v_dot2_f32_bf16 v107, v201, v22, v107
    v_dot2_f32_bf16 v112, v204, v1, v112
    v_dot2_f32_bf16 v113, v205, v1, v113
    v_dot2_f32_bf16 v114, v204, v22, v114
    v_dot2_f32_bf16 v115, v205, v22, v115
    v_dot2_f32_bf16 v120, v208, v1, v120
    v_dot2_f32_bf16 v121, v209, v1, v121
    v_dot2_f32_bf16 v122, v208, v22, v122
    v_dot2_f32_bf16 v123, v209, v22, v123
    v_dot2_f32_bf16 v128, v212, v1, v128
    v_dot2_f32_bf16 v129, v213, v1, v129
    v_dot2_f32_bf16 v130, v212, v22, v130
    v_dot2_f32_bf16 v131, v213, v22, v131
    s_add_u32 s69, s96, 6291456
    s_add_u32 s68, s96, 4194304
    v_pk_fma_f32 v[88:89], v[72:73], v[104:105], v[88:89]
    v_pk_fma_f32 v[90:91], v[74:75], v[106:107], v[90:91]
    v_pk_mul_f32 v[24:25], v[88:89], v[216:217] op_sel:[0,1] op_sel_hi:[1,1]
    v_pk_mul_f32 v[26:27], v[90:91], v[216:217] op_sel:[0,1] op_sel_hi:[1,1]
    v_cvt_pk_bf16_f32 v144, v24, v25
    v_cvt_pk_bf16_f32 v145, v26, v27
    ds_write_b64 v219, v[144:145] offset:0
    v_pk_fma_f32 v[92:93], v[76:77], v[112:113], v[92:93]
    v_pk_fma_f32 v[94:95], v[78:79], v[114:115], v[94:95]
    v_pk_mul_f32 v[28:29], v[92:93], v[216:217] op_sel:[0,1] op_sel_hi:[1,1]
    v_pk_mul_f32 v[30:31], v[94:95], v[216:217] op_sel:[0,1] op_sel_hi:[1,1]
    v_cvt_pk_bf16_f32 v146, v28, v29
    v_cvt_pk_bf16_f32 v147, v30, v31
    ds_write_b64 v219, v[146:147] offset:512
    v_pk_fma_f32 v[96:97], v[80:81], v[120:121], v[96:97]
    v_pk_fma_f32 v[98:99], v[82:83], v[122:123], v[98:99]
    v_pk_mul_f32 v[32:33], v[96:97], v[216:217] op_sel:[0,1] op_sel_hi:[1,1]
    v_pk_mul_f32 v[34:35], v[98:99], v[216:217] op_sel:[0,1] op_sel_hi:[1,1]
    v_cvt_pk_bf16_f32 v148, v32, v33
    v_cvt_pk_bf16_f32 v149, v34, v35
    ds_write_b64 v219, v[148:149] offset:1024
    v_pk_fma_f32 v[100:101], v[84:85], v[128:129], v[100:101]
    v_pk_fma_f32 v[102:103], v[86:87], v[130:131], v[102:103]
    v_pk_mul_f32 v[36:37], v[100:101], v[216:217] op_sel:[0,1] op_sel_hi:[1,1]
    v_pk_mul_f32 v[38:39], v[102:103], v[216:217] op_sel:[0,1] op_sel_hi:[1,1]
    v_cvt_pk_bf16_f32 v150, v36, v37
    v_cvt_pk_bf16_f32 v151, v38, v39
    ds_write_b64 v219, v[150:151] offset:1536
    v_cvt_pk_bf16_f32 v136, v88, v89
    v_cvt_pk_bf16_f32 v137, v90, v91
    ds_write_b64 v219, v[136:137] offset:2048
    v_cvt_pk_bf16_f32 v138, v92, v93
    v_cvt_pk_bf16_f32 v139, v94, v95
    ds_write_b64 v219, v[138:139] offset:2560
    v_cvt_pk_bf16_f32 v140, v96, v97
    v_cvt_pk_bf16_f32 v141, v98, v99
    ds_write_b64 v219, v[140:141] offset:3072
    v_cvt_pk_bf16_f32 v142, v100, v101
    v_cvt_pk_bf16_f32 v143, v102, v103
    ds_write_b64 v219, v[142:143] offset:3584
    s_waitcnt lgkmcnt(4)
    ds_read_b128 v[152:155], v220 offset:0
    ds_read_b128 v[156:159], v220 offset:1024
    s_waitcnt lgkmcnt(2)
    ds_read_b128 v[160:163], v220 offset:2048
    ds_read_b128 v[164:167], v220 offset:3072
    s_waitcnt lgkmcnt(3)
    buffer_store_dwordx4 v[152:155], v221, s[36:39], s69 offen sc1
    s_waitcnt lgkmcnt(2)
    buffer_store_dwordx4 v[156:159], v222, s[36:39], s69 offen sc1
    s_waitcnt lgkmcnt(1)
    buffer_store_dwordx4 v[160:163], v221, s[36:39], s68 offen sc1
    s_waitcnt lgkmcnt(0)
    buffer_store_dwordx4 v[164:167], v222, s[36:39], s68 offen sc1
    s_waitcnt vmcnt(0)
L_convdone:
    v_xor_b32 v7, v6, v4
    v_and_b32 v7, 1, v7
    v_lshrrev_b32 v45, 2, v6
    v_or_b32 v7, v7, v45
    v_lshrrev_b32 v45, 1, v6
    v_lshlrev_b32 v45, 10, v45
    v_lshrrev_b32 v46, 1, v4
    v_lshl_add_u32 v45, v46, 4, v45
    v_add_u32 v45, 147968, v45
    v_cmp_eq_u32 vcc, 0, v7
    v_mov_b32 v47, 150016
    s_nop 0
    v_cndmask_b32 v47, v47, v45, vcc
    v_mov_b32 v46, 32
    v_cndmask_b32 v46, 0, v46, vcc
    v_add_u32 v232, s89, v246
    v_add_u32 v233, s89, v247
    v_add_u32 v234, s89, v248
    v_add_u32 v235, s89, v249
    v_lshrrev_b32 v5, 3, v2
    v_and_b32 v57, 2, v5
    v_lshlrev_b32 v57, 5, v57
    v_and_b32 v56, 7, v2
    v_lshlrev_b32 v56, 4, v56
    v_xor_b32 v56, v56, v57
    v_mul_u32_u24 v5, 4096, v5
    v_add_u32 v56, v56, v5
    v_xor_b32 v57, 32, v56
    v_bfe_u32 v5, v56, 6, 1
    v_lshl_add_u32 v58, v5, 6, v56
    v_lshl_add_u32 v59, v5, 6, v57
    v_add_u32 v57, 31744, v57
    v_add_u32 v59, 31744, v59
    s_lshl_b32 s54, s3, 16
    s_lshl_b32 s55, s92, 8
    s_add_u32 s54, s54, s55
    s_and_b32 s56, s88, 1
    s_lshl_b32 s56, s56, 7
    s_add_u32 s56, s56, 4194304
    s_cmp_ge_u32 s88, 14
    s_cselect_b32 s56, s56, 6291456
    s_add_u32 s54, s54, s56
    s_add_u32 s8, s36, s54
    s_addc_u32 s9, s37, 0
    v_add_u32 v60, 128, v56
    v_add_u32 v61, 128, v57
    s_lshl_b32 s56, s3, 11
    s_lshl_b32 s59, s94, 18
    v_lshrrev_b32 v5, 5, v2
    v_bfe_u32 v6, v2, 2, 2
    v_lshl_add_u32 v8, v5, 3, v6
    v_lshlrev_b32 v8, 7, v8
    v_and_b32 v6, 2, v6
    v_or_b32 v6, v6, v5
    v_bfe_u32 v5, v2, 4, 1
    v_xor_b32 v6, v6, v5
    v_lshl_add_u32 v8, v6, 5, v8
    v_and_b32 v5, 3, v2
    v_lshl_add_u32 v8, v5, 3, v8
    v_xor_b32 v9, 64, v8
    v_add_u32 v10, 0x10000, v8
    v_add_u32 v11, 0x10000, v9
    v_lshlrev_b32 v18, 4, v2
    s_mul_i32 s57, s92, 458752
    s_lshl_b32 s58, s88, 13
    s_add_u32 s57, s57, s58
    s_add_u32 s57, s57, s56
    s_add_u32 s57, s57, 8388608
    v_lshrrev_b32 v5, 5, v2
    v_bfe_u32 v6, v2, 2, 2
    v_lshl_add_u32 v44, v5, 2, v6
    v_lshlrev_b32 v44, 7, v44
    v_and_b32 v6, 2, v6
    v_bfe_u32 v5, v2, 4, 1
    v_xor_b32 v6, v6, v5
    v_lshl_add_u32 v44, v6, 5, v44
    v_and_b32 v5, 3, v2
    v_lshl_add_u32 v44, v5, 3, v44
    s_add_u32 s60, s56, 131072
    v_add_u32 v44, s60, v44
    v_xor_b32 v45, 32, v44
    v_xor_b32 v42, 64, v44
    v_xor_b32 v43, 96, v44
    s_lshl_b32 s61, s92, 11
    s_add_u32 s61, s61, 16908288
    s_lshr_b32 s62, s0, 4
    s_lshl_b32 s62, s62, 1
    s_bfe_u32 s63, s0, 0x20002
    s_lshl_b32 s63, s63, 6
    s_add_u32 s62, s62, s63
    s_lshl_b32 s62, s62, 7
    s_add_u32 s63, s62, 17842176
    s_add_u32 s62, s62, 17989632
    v_min_u32 v14, 13, v2
    v_and_b32 v5, 1, v14
    v_lshrrev_b32 v14, 1, v14
    v_lshlrev_b32 v14, 10, v14
    v_lshl_add_u32 v14, v5, 7, v14
    s_waitcnt vmcnt(8)
    s_barrier
    s_cmp_eq_u32 s3, 3
    s_cbranch_scc1 L_s3a_7
    ds_read_b64_tr_b16 a[128:129], v232 offset:0
    ds_read_b64_tr_b16 a[130:131], v233 offset:1024
    ds_read_b64_tr_b16 a[132:133], v234 offset:0
    ds_read_b64_tr_b16 a[134:135], v235 offset:1024
    ds_read_b64_tr_b16 a[136:137], v232 offset:2048
    ds_read_b64_tr_b16 a[138:139], v233 offset:3072
    ds_read_b64_tr_b16 a[140:141], v234 offset:2048
    ds_read_b64_tr_b16 a[142:143], v235 offset:3072
    ds_read_b64_tr_b16 a[144:145], v232 offset:4096
    ds_read_b64_tr_b16 a[146:147], v233 offset:5120
    ds_read_b64_tr_b16 a[148:149], v234 offset:4096
    ds_read_b64_tr_b16 a[150:151], v235 offset:5120
    ds_read_b64_tr_b16 a[152:153], v232 offset:6144
    ds_read_b64_tr_b16 a[154:155], v233 offset:7168
    ds_read_b64_tr_b16 a[156:157], v234 offset:6144
    ds_read_b64_tr_b16 a[158:159], v235 offset:7168
    ds_read_b64_tr_b16 a[160:161], v232 offset:8192
    ds_read_b64_tr_b16 a[162:163], v233 offset:9216
    ds_read_b64_tr_b16 a[164:165], v234 offset:8192
    ds_read_b64_tr_b16 a[166:167], v235 offset:9216
    ds_read_b64_tr_b16 a[168:169], v232 offset:10240
    ds_read_b64_tr_b16 a[170:171], v233 offset:11264
    ds_read_b64_tr_b16 a[172:173], v234 offset:10240
    ds_read_b64_tr_b16 a[174:175], v235 offset:11264
    ds_read_b64_tr_b16 a[176:177], v232 offset:12288
    ds_read_b64_tr_b16 a[178:179], v233 offset:13312
    ds_read_b64_tr_b16 a[180:181], v234 offset:12288
    ds_read_b64_tr_b16 a[182:183], v235 offset:13312
    ds_read_b64_tr_b16 a[184:185], v232 offset:14336
    ds_read_b64_tr_b16 a[186:187], v233 offset:15360
    ds_read_b64_tr_b16 a[188:189], v234 offset:14336
    ds_read_b64_tr_b16 a[190:191], v235 offset:15360
    ds_read_b64_tr_b16 a[192:193], v232 offset:16384
    ds_read_b64_tr_b16 a[194:195], v233 offset:17408
    ds_read_b64_tr_b16 a[196:197], v234 offset:16384
    ds_read_b64_tr_b16 a[198:199], v235 offset:17408
    ds_read_b64_tr_b16 a[200:201], v232 offset:18432
    ds_read_b64_tr_b16 a[202:203], v233 offset:19456
    ds_read_b64_tr_b16 a[204:205], v234 offset:18432
    ds_read_b64_tr_b16 a[206:207], v235 offset:19456
    ds_read_b64_tr_b16 a[208:209], v232 offset:20480
    ds_read_b64_tr_b16 a[210:211], v233 offset:21504
    ds_read_b64_tr_b16 a[212:213], v234 offset:20480
    ds_read_b64_tr_b16 a[214:215], v235 offset:21504
    ds_read_b64_tr_b16 a[216:217], v232 offset:22528
    ds_read_b64_tr_b16 a[218:219], v233 offset:23552
    ds_read_b64_tr_b16 a[220:221], v234 offset:22528
    ds_read_b64_tr_b16 a[222:223], v235 offset:23552
    s_waitcnt vmcnt(0)
    ds_read_b64_tr_b16 a[224:225], v232 offset:24576
    ds_read_b64_tr_b16 a[226:227], v233 offset:25600
    ds_read_b64_tr_b16 a[228:229], v234 offset:24576
    ds_read_b64_tr_b16 a[230:231], v235 offset:25600
    ds_read_b64_tr_b16 a[232:233], v232 offset:26624
    ds_read_b64_tr_b16 a[234:235], v233 offset:27648
    ds_read_b64_tr_b16 a[236:237], v234 offset:26624
    ds_read_b64_tr_b16 a[238:239], v235 offset:27648
    ds_read_b64_tr_b16 a[240:241], v232 offset:28672
    ds_read_b64_tr_b16 a[242:243], v233 offset:29696
    ds_read_b64_tr_b16 a[244:245], v234 offset:28672
    ds_read_b64_tr_b16 a[246:247], v235 offset:29696
    ds_read_b64_tr_b16 a[248:249], v232 offset:30720
    ds_read_b64_tr_b16 a[250:251], v233 offset:31744
    ds_read_b64_tr_b16 a[252:253], v234 offset:30720
    ds_read_b64_tr_b16 a[254:255], v235 offset:31744
    s_cmp_eq_u32 s3, 2
    s_cbranch_scc0 L_now3w2
    s_lshl_b32 s65, s93, 7
    s_add_u32 s65, s65, 1376256
    s_waitcnt lgkmcnt(0)
    s_add_u32 s98, s91, 0
    s_add_u32 m0, s89, 0
    s_cmp_ge_u32 s98, 7
    s_cselect_b32 s86, 7, 0
    s_sub_u32 s98, s98, s86
    s_lshl_b32 s86, s98, 16
    s_add_u32 s86, s86, s65
    buffer_load_dwordx4 v228, s[24:27], s86 offen offset:0 lds
    buffer_load_dwordx4 v229, s[24:27], s86 offen offset:1024 lds
    buffer_load_dwordx4 v230, s[24:27], s86 offen offset:2048 lds
    buffer_load_dwordx4 v231, s[24:27], s86 offen offset:3072 lds
    s_add_u32 m0, m0, 4096
    s_add_u32 s86, s86, 32768
    buffer_load_dwordx4 v228, s[24:27], s86 offen offset:0 lds
    buffer_load_dwordx4 v229, s[24:27], s86 offen offset:1024 lds
    buffer_load_dwordx4 v230, s[24:27], s86 offen offset:2048 lds
    buffer_load_dwordx4 v231, s[24:27], s86 offen offset:3072 lds
    s_add_u32 s98, s91, 1
    s_add_u32 m0, s89, 8192
    s_cmp_ge_u32 s98, 7
    s_cselect_b32 s86, 7, 0
    s_sub_u32 s98, s98, s86
    s_lshl_b32 s86, s98, 16
    s_add_u32 s86, s86, s65
    buffer_load_dwordx4 v228, s[24:27], s86 offen offset:0 lds
    buffer_load_dwordx4 v229, s[24:27], s86 offen offset:1024 lds
    buffer_load_dwordx4 v230, s[24:27], s86 offen offset:2048 lds
    buffer_load_dwordx4 v231, s[24:27], s86 offen offset:3072 lds
    s_add_u32 m0, m0, 4096
    s_add_u32 s86, s86, 32768
    buffer_load_dwordx4 v228, s[24:27], s86 offen offset:0 lds
    buffer_load_dwordx4 v229, s[24:27], s86 offen offset:1024 lds
    buffer_load_dwordx4 v230, s[24:27], s86 offen offset:2048 lds
    buffer_load_dwordx4 v231, s[24:27], s86 offen offset:3072 lds
    s_add_u32 s98, s91, 2
    s_add_u32 m0, s89, 16384
    s_cmp_ge_u32 s98, 7
    s_cselect_b32 s86, 7, 0
    s_sub_u32 s98, s98, s86
    s_lshl_b32 s86, s98, 16
    s_add_u32 s86, s86, s65
    buffer_load_dwordx4 v228, s[24:27], s86 offen offset:0 lds
    buffer_load_dwordx4 v229, s[24:27], s86 offen offset:1024 lds
    buffer_load_dwordx4 v230, s[24:27], s86 offen offset:2048 lds
    buffer_load_dwordx4 v231, s[24:27], s86 offen offset:3072 lds
    s_add_u32 m0, m0, 4096
    s_add_u32 s86, s86, 32768
    buffer_load_dwordx4 v228, s[24:27], s86 offen offset:0 lds
    buffer_load_dwordx4 v229, s[24:27], s86 offen offset:1024 lds
    buffer_load_dwordx4 v230, s[24:27], s86 offen offset:2048 lds
    buffer_load_dwordx4 v231, s[24:27], s86 offen offset:3072 lds
    s_add_u32 s98, s91, 3
    s_add_u32 m0, s89, 24576
    s_cmp_ge_u32 s98, 7
    s_cselect_b32 s86, 7, 0
    s_sub_u32 s98, s98, s86
    s_lshl_b32 s86, s98, 16
    s_add_u32 s86, s86, s65
    buffer_load_dwordx4 v228, s[24:27], s86 offen offset:0 lds
    buffer_load_dwordx4 v229, s[24:27], s86 offen offset:1024 lds
    buffer_load_dwordx4 v230, s[24:27], s86 offen offset:2048 lds
    buffer_load_dwordx4 v231, s[24:27], s86 offen offset:3072 lds
    s_add_u32 m0, m0, 4096
    s_add_u32 s86, s86, 32768
    buffer_load_dwordx4 v228, s[24:27], s86 offen offset:0 lds
    buffer_load_dwordx4 v229, s[24:27], s86 offen offset:1024 lds
    buffer_load_dwordx4 v230, s[24:27], s86 offen offset:2048 lds
    buffer_load_dwordx4 v231, s[24:27], s86 offen offset:3072 lds
L_now3w2:
    s_branch L_s3b_7
L_s3a_7:
    s_lshl_b32 s98, s2, 7
    s_add_u32 s98, s98, 17924096
    s_mov_b64 exec, 1
    v_mov_b32 v252, 0
    v_mov_b32 v254, s84
    v_mov_b32 v255, s85
    buffer_store_dwordx2 v[254:255], v252, s[36:39], s98 offen sc1
    s_mov_b64 exec, -1
    ds_read_b64_tr_b16 a[0:1], v242 offset:0
    ds_read_b64_tr_b16 a[2:3], v242 offset:512
    ds_read_b64_tr_b16 a[64:65], v243 offset:0
    ds_read_b64_tr_b16 a[66:67], v243 offset:512
    ds_read_b64_tr_b16 a[4:5], v242 offset:2048
    ds_read_b64_tr_b16 a[6:7], v242 offset:2560
    ds_read_b64_tr_b16 a[68:69], v243 offset:2048
    ds_read_b64_tr_b16 a[70:71], v243 offset:2560
    ds_read_b64_tr_b16 a[8:9], v242 offset:4096
    ds_read_b64_tr_b16 a[10:11], v242 offset:4608
    ds_read_b64_tr_b16 a[72:73], v243 offset:4096
    ds_read_b64_tr_b16 a[74:75], v243 offset:4608
    ds_read_b64_tr_b16 a[12:13], v242 offset:6144
    ds_read_b64_tr_b16 a[14:15], v242 offset:6656
    ds_read_b64_tr_b16 a[76:77], v243 offset:6144
    ds_read_b64_tr_b16 a[78:79], v243 offset:6656
    ds_read_b64_tr_b16 a[16:17], v242 offset:8192
    ds_read_b64_tr_b16 a[18:19], v242 offset:8704
    ds_read_b64_tr_b16 a[80:81], v243 offset:8192
    ds_read_b64_tr_b16 a[82:83], v243 offset:8704
    ds_read_b64_tr_b16 a[20:21], v242 offset:10240
    ds_read_b64_tr_b16 a[22:23], v242 offset:10752
    ds_read_b64_tr_b16 a[84:85], v243 offset:10240
    ds_read_b64_tr_b16 a[86:87], v243 offset:10752
    ds_read_b64_tr_b16 a[24:25], v242 offset:12288
    ds_read_b64_tr_b16 a[26:27], v242 offset:12800
    ds_read_b64_tr_b16 a[88:89], v243 offset:12288
    ds_read_b64_tr_b16 a[90:91], v243 offset:12800
    ds_read_b64_tr_b16 a[28:29], v242 offset:14336
    ds_read_b64_tr_b16 a[30:31], v242 offset:14848
    ds_read_b64_tr_b16 a[92:93], v243 offset:14336
    ds_read_b64_tr_b16 a[94:95], v243 offset:14848
    ds_read_b64_tr_b16 a[32:33], v242 offset:16384
    ds_read_b64_tr_b16 a[34:35], v242 offset:16896
    ds_read_b64_tr_b16 a[96:97], v243 offset:16384
    ds_read_b64_tr_b16 a[98:99], v243 offset:16896
    ds_read_b64_tr_b16 a[36:37], v242 offset:18432
    ds_read_b64_tr_b16 a[38:39], v242 offset:18944
    ds_read_b64_tr_b16 a[100:101], v243 offset:18432
    ds_read_b64_tr_b16 a[102:103], v243 offset:18944
    ds_read_b64_tr_b16 a[40:41], v242 offset:20480
    ds_read_b64_tr_b16 a[42:43], v242 offset:20992
    ds_read_b64_tr_b16 a[104:105], v243 offset:20480
    ds_read_b64_tr_b16 a[106:107], v243 offset:20992
    ds_read_b64_tr_b16 a[44:45], v242 offset:22528
    ds_read_b64_tr_b16 a[46:47], v242 offset:23040
    ds_read_b64_tr_b16 a[108:109], v243 offset:22528
    ds_read_b64_tr_b16 a[110:111], v243 offset:23040
    ds_read_b64_tr_b16 a[48:49], v242 offset:24576
    ds_read_b64_tr_b16 a[50:51], v242 offset:25088
    ds_read_b64_tr_b16 a[112:113], v243 offset:24576
    ds_read_b64_tr_b16 a[114:115], v243 offset:25088
    ds_read_b64_tr_b16 a[52:53], v242 offset:26624
    ds_read_b64_tr_b16 a[54:55], v242 offset:27136
    ds_read_b64_tr_b16 a[116:117], v243 offset:26624
    ds_read_b64_tr_b16 a[118:119], v243 offset:27136
    ds_read_b64_tr_b16 a[56:57], v242 offset:28672
    ds_read_b64_tr_b16 a[58:59], v242 offset:29184
    ds_read_b64_tr_b16 a[120:121], v243 offset:28672
    ds_read_b64_tr_b16 a[122:123], v243 offset:29184
    ds_read_b64_tr_b16 a[60:61], v242 offset:30720
    ds_read_b64_tr_b16 a[62:63], v242 offset:31232
    ds_read_b64_tr_b16 a[124:125], v243 offset:30720
    ds_read_b64_tr_b16 a[126:127], v243 offset:31232
    v_add_u32 v232, 65536, v246
    v_add_u32 v233, 65536, v247
    v_add_u32 v234, 65536, v248
    v_add_u32 v235, 65536, v249
L_s3b_7:
    ds_read_b128 v[192:195], v47
    v_add_u32 v47, v47, v46
    ds_read_b128 v[196:199], v47
    v_add_u32 v47, v47, v46
    ds_read_b128 v[200:203], v47
    v_add_u32 v47, v47, v46
    ds_read_b128 v[204:207], v47
    v_add_u32 v47, v47, v46
    ds_read_b128 v[208:211], v47
    v_add_u32 v47, v47, v46
    ds_read_b128 v[212:215], v47
    v_add_u32 v47, v47, v46
    ds_read_b128 v[216:219], v47
    v_add_u32 v47, v47, v46
    ds_read_b128 v[220:223], v47
    v_add_u32 v47, v47, v46
    s_waitcnt lgkmcnt(7)
    v_mfma_f32_16x16x32_bf16 v[48:51], a[0:3], v[192:195], 0
    ds_read_b128 v[192:195], v47
    v_add_u32 v47, v47, v46
    s_waitcnt lgkmcnt(7)
    v_mfma_f32_16x16x32_bf16 v[48:51], a[4:7], v[196:199], v[48:51]
    ds_read_b128 v[196:199], v47
    v_add_u32 v47, v47, v46
    s_waitcnt lgkmcnt(7)
    v_mfma_f32_16x16x32_bf16 v[48:51], a[8:11], v[200:203], v[48:51]
    ds_read_b128 v[200:203], v47
    v_add_u32 v47, v47, v46
    s_waitcnt lgkmcnt(7)
    v_mfma_f32_16x16x32_bf16 v[48:51], a[12:15], v[204:207], v[48:51]
    ds_read_b128 v[204:207], v47
    v_add_u32 v47, v47, v46
    s_waitcnt lgkmcnt(7)
    v_mfma_f32_16x16x32_bf16 v[48:51], a[16:19], v[208:211], v[48:51]
    ds_read_b128 v[208:211], v47
    v_add_u32 v47, v47, v46
    s_waitcnt lgkmcnt(7)
    v_mfma_f32_16x16x32_bf16 v[48:51], a[20:23], v[212:215], v[48:51]
    ds_read_b128 v[212:215], v47
    v_add_u32 v47, v47, v46
    s_waitcnt lgkmcnt(7)
    v_mfma_f32_16x16x32_bf16 v[48:51], a[24:27], v[216:219], v[48:51]
    ds_read_b128 v[216:219], v47
    v_add_u32 v47, v47, v46
    s_waitcnt lgkmcnt(7)
    v_mfma_f32_16x16x32_bf16 v[48:51], a[28:31], v[220:223], v[48:51]
    ds_read_b128 v[220:223], v47
    v_add_u32 v47, v47, v46
    s_waitcnt lgkmcnt(7)
    v_mfma_f32_16x16x32_bf16 v[48:51], a[32:35], v[192:195], v[48:51]
    ds_read_b128 v[192:195], v47
    v_add_u32 v47, v47, v46
    s_waitcnt lgkmcnt(7)
    v_mfma_f32_16x16x32_bf16 v[48:51], a[36:39], v[196:199], v[48:51]
    ds_read_b128 v[196:199], v47
    v_add_u32 v47, v47, v46
    s_waitcnt lgkmcnt(7)
    v_mfma_f32_16x16x32_bf16 v[48:51], a[40:43], v[200:203], v[48:51]
    ds_read_b128 v[200:203], v47
    v_add_u32 v47, v47, v46
    s_waitcnt lgkmcnt(7)
    v_mfma_f32_16x16x32_bf16 v[48:51], a[44:47], v[204:207], v[48:51]
    ds_read_b128 v[204:207], v47
    v_add_u32 v47, v47, v46
    s_waitcnt lgkmcnt(7)
    v_mfma_f32_16x16x32_bf16 v[48:51], a[48:51], v[208:211], v[48:51]
    ds_read_b128 v[208:211], v47
    v_add_u32 v47, v47, v46
    s_waitcnt lgkmcnt(7)
    v_mfma_f32_16x16x32_bf16 v[48:51], a[52:55], v[212:215], v[48:51]
    ds_read_b128 v[212:215], v47
    v_add_u32 v47, v47, v46
    s_waitcnt lgkmcnt(7)
    v_mfma_f32_16x16x32_bf16 v[48:51], a[56:59], v[216:219], v[48:51]
    ds_read_b128 v[216:219], v47
    v_add_u32 v47, v47, v46
    s_waitcnt lgkmcnt(7)
    v_mfma_f32_16x16x32_bf16 v[48:51], a[60:63], v[220:223], v[48:51]
    ds_read_b128 v[220:223], v47
    v_add_u32 v47, v47, v46
    s_waitcnt lgkmcnt(7)
    v_mfma_f32_16x16x32_bf16 v[48:51], a[64:67], v[192:195], v[48:51]
    ds_read_b128 v[192:195], v47
    v_add_u32 v47, v47, v46
    s_waitcnt lgkmcnt(7)
    v_mfma_f32_16x16x32_bf16 v[48:51], a[68:71], v[196:199], v[48:51]
    ds_read_b128 v[196:199], v47
    v_add_u32 v47, v47, v46
    s_waitcnt lgkmcnt(7)
    v_mfma_f32_16x16x32_bf16 v[48:51], a[72:75], v[200:203], v[48:51]
    ds_read_b128 v[200:203], v47
    v_add_u32 v47, v47, v46
    s_waitcnt lgkmcnt(7)
    v_mfma_f32_16x16x32_bf16 v[48:51], a[76:79], v[204:207], v[48:51]
    ds_read_b128 v[204:207], v47
    v_add_u32 v47, v47, v46
    s_waitcnt lgkmcnt(7)
    v_mfma_f32_16x16x32_bf16 v[48:51], a[80:83], v[208:211], v[48:51]
    ds_read_b128 v[208:211], v47
    v_add_u32 v47, v47, v46
    s_waitcnt lgkmcnt(7)
    v_mfma_f32_16x16x32_bf16 v[48:51], a[84:87], v[212:215], v[48:51]
    ds_read_b128 v[212:215], v47
    v_add_u32 v47, v47, v46
    s_waitcnt lgkmcnt(7)
    v_mfma_f32_16x16x32_bf16 v[48:51], a[88:91], v[216:219], v[48:51]
    ds_read_b128 v[216:219], v47
    v_add_u32 v47, v47, v46
    s_waitcnt lgkmcnt(7)
    v_mfma_f32_16x16x32_bf16 v[48:51], a[92:95], v[220:223], v[48:51]
    ds_read_b128 v[220:223], v47
    v_add_u32 v47, v47, v46
    s_waitcnt lgkmcnt(7)
    v_mfma_f32_16x16x32_bf16 v[48:51], a[96:99], v[192:195], v[48:51]
    s_waitcnt lgkmcnt(6)
    v_mfma_f32_16x16x32_bf16 v[48:51], a[100:103], v[196:199], v[48:51]
    s_waitcnt lgkmcnt(5)
    v_mfma_f32_16x16x32_bf16 v[48:51], a[104:107], v[200:203], v[48:51]
    s_waitcnt lgkmcnt(4)
    v_mfma_f32_16x16x32_bf16 v[48:51], a[108:111], v[204:207], v[48:51]
    s_waitcnt lgkmcnt(3)
    v_mfma_f32_16x16x32_bf16 v[48:51], a[112:115], v[208:211], v[48:51]
    s_waitcnt lgkmcnt(2)
    v_mfma_f32_16x16x32_bf16 v[48:51], a[116:119], v[212:215], v[48:51]
    s_waitcnt lgkmcnt(1)
    v_mfma_f32_16x16x32_bf16 v[48:51], a[120:123], v[216:219], v[48:51]
    s_waitcnt lgkmcnt(0)
    v_mfma_f32_16x16x32_bf16 v[48:51], a[124:127], v[220:223], v[48:51]
    v_lshrrev_b32 v4, 4, v2
    v_and_b32 v6, 15, v2
    s_lshl_b32 s67, s3, 9
    s_add_u32 s67, s67, 150144
    v_and_b32 v5, 1, v6
    v_lshlrev_b32 v5, 6, v5
    v_lshl_add_u32 v5, v4, 4, v5
    v_lshrrev_b32 v7, 1, v6
    v_lshl_add_u32 v5, v7, 8, v5
    v_add_u32 v5, s67, v5
    s_mov_b32 exec_lo, 0x000f000f
    s_mov_b32 exec_hi, 0x000f000f
    ds_write_b128 v5, v[48:51]
    s_mov_b64 exec, -1
    v_lshrrev_b32 v5, 5, v2
    v_lshlrev_b32 v5, 4, v5
    v_add_u32 v5, s67, v5
    s_waitcnt lgkmcnt(0)
    ds_read_b128 v[64:67], v5 offset:0
    ds_read_b128 v[80:83], v5 offset:256
    ds_read_b128 v[68:71], v5 offset:32
    ds_read_b128 v[84:87], v5 offset:288
    ds_read_b128 v[72:75], v5 offset:64
    ds_read_b128 v[88:91], v5 offset:320
    ds_read_b128 v[76:79], v5 offset:96
    ds_read_b128 v[92:95], v5 offset:352
    v_mov_b32 v6, 0xbfb8aa3b
    s_waitcnt lgkmcnt(6)
    v_pk_mul_f32 v[80:81], v[80:81], v[6:7] op_sel_hi:[1,0]
    v_pk_mul_f32 v[82:83], v[82:83], v[6:7] op_sel_hi:[1,0]
    s_waitcnt lgkmcnt(4)
    v_pk_mul_f32 v[84:85], v[84:85], v[6:7] op_sel_hi:[1,0]
    v_pk_mul_f32 v[86:87], v[86:87], v[6:7] op_sel_hi:[1,0]
    s_waitcnt lgkmcnt(2)
    v_pk_mul_f32 v[88:89], v[88:89], v[6:7] op_sel_hi:[1,0]
    v_pk_mul_f32 v[90:91], v[90:91], v[6:7] op_sel_hi:[1,0]
    s_waitcnt lgkmcnt(0)
    v_pk_mul_f32 v[92:93], v[92:93], v[6:7] op_sel_hi:[1,0]
    v_pk_mul_f32 v[94:95], v[94:95], v[6:7] op_sel_hi:[1,0]
    s_cmp_eq_u32 s3, 0
    s_cbranch_scc0 L_np2
    v_lshlrev_b32 v116, 7, v2
    s_mov_b64 s[76:77], -1
    s_mov_b64 s[78:79], -1
    v_add_u32 v117, 8192, v116
    s_mov_b64 s[80:81], -1
    v_add_u32 v118, 16384, v116
    s_mov_b64 s[82:83], -1
    v_add_u32 v119, 24576, v116
    s_mov_b32 s98, 17924096
    s_mov_b32 s97, 0x40000
L_lf8:
    s_or_b64 exec, s[76:77], 1
    buffer_load_dwordx2 v[100:101], v116, s[36:39], s98 offen sc1
    s_or_b64 exec, s[78:79], 1
    buffer_load_dwordx2 v[102:103], v117, s[36:39], s98 offen sc1
    s_or_b64 exec, s[80:81], 1
    buffer_load_dwordx2 v[104:105], v118, s[36:39], s98 offen sc1
    s_or_b64 exec, s[82:83], 1
    buffer_load_dwordx2 v[106:107], v119, s[36:39], s98 offen sc1
    s_waitcnt vmcnt(0)
    s_mov_b64 exec, s[76:77]
    v_cmp_ne_u64 s[76:77], s[84:85], v[100:101]
    s_mov_b64 exec, s[78:79]
    v_cmp_ne_u64 s[78:79], s[84:85], v[102:103]
    s_mov_b64 exec, s[80:81]
    v_cmp_ne_u64 s[80:81], s[84:85], v[104:105]
    s_mov_b64 exec, s[82:83]
    v_cmp_ne_u64 s[82:83], s[84:85], v[106:107]
    s_or_b64 vcc, s[76:77], s[78:79]
    s_or_b64 vcc, vcc, s[80:81]
    s_or_b64 vcc, vcc, s[82:83]
    s_cbranch_scc0 L_lfx8
    s_bcnt1_i32_b64 s86, vcc
    s_cmp_gt_u32 s86, 24
    s_cbranch_scc0 L_lfs8
    s_sleep 24
L_lfs8:
    s_sleep 1
    s_sub_u32 s97, s97, 1
    s_cbranch_scc0 L_lf8
L_lfx8:
    s_mov_b64 exec, -1
L_np2:
    s_waitcnt vmcnt(0)
    s_barrier
    s_lshl_b32 s89, s3, 14
    s_cmp_ge_u32 s88, 14
    s_cbranch_scc1 L_stat
    s_add_u32 m0, s56, 0
    s_and_b32 s59, s59, 0x1fffff
    buffer_load_dwordx4 v56, s[8:11], s59 offen sc1 lds
    buffer_load_dwordx4 v57, s[8:11], s59 offen offset:1024 sc1 lds
    s_add_u32 s59, s59, 262144
    s_add_u32 m0, s56, 8192
    s_and_b32 s59, s59, 0x1fffff
    buffer_load_dwordx4 v56, s[8:11], s59 offen sc1 lds
    buffer_load_dwordx4 v57, s[8:11], s59 offen offset:1024 sc1 lds
    s_add_u32 s59, s59, 262144
    s_add_u32 m0, s56, 16384
    s_and_b32 s59, s59, 0x1fffff
    buffer_load_dwordx4 v56, s[8:11], s59 offen sc1 lds
    buffer_load_dwordx4 v57, s[8:11], s59 offen offset:1024 sc1 lds
    s_add_u32 s59, s59, 262144
    s_add_u32 m0, s56, 24576
    s_and_b32 s59, s59, 0x1fffff
    buffer_load_dwordx4 v56, s[8:11], s59 offen sc1 lds
    buffer_load_dwordx4 v57, s[8:11], s59 offen offset:1024 sc1 lds
    s_add_u32 s59, s59, 262144
    s_cmp_eq_u32 s3, 3
    s_cbranch_scc0 L_w3_9
    ds_read_b64_tr_b16 a[128:129], v232 offset:0
    ds_read_b64_tr_b16 a[130:131], v233 offset:1024
    ds_read_b64_tr_b16 a[132:133], v234 offset:0
    ds_read_b64_tr_b16 a[134:135], v235 offset:1024
    ds_read_b64_tr_b16 a[136:137], v232 offset:2048
    ds_read_b64_tr_b16 a[138:139], v233 offset:3072
    ds_read_b64_tr_b16 a[140:141], v234 offset:2048
    ds_read_b64_tr_b16 a[142:143], v235 offset:3072
    ds_read_b64_tr_b16 a[144:145], v232 offset:4096
    ds_read_b64_tr_b16 a[146:147], v233 offset:5120
    ds_read_b64_tr_b16 a[148:149], v234 offset:4096
    ds_read_b64_tr_b16 a[150:151], v235 offset:5120
    ds_read_b64_tr_b16 a[152:153], v232 offset:6144
    ds_read_b64_tr_b16 a[154:155], v233 offset:7168
    ds_read_b64_tr_b16 a[156:157], v234 offset:6144
    ds_read_b64_tr_b16 a[158:159], v235 offset:7168
    ds_read_b64_tr_b16 a[160:161], v232 offset:8192
    ds_read_b64_tr_b16 a[162:163], v233 offset:9216
    ds_read_b64_tr_b16 a[164:165], v234 offset:8192
    ds_read_b64_tr_b16 a[166:167], v235 offset:9216
    ds_read_b64_tr_b16 a[168:169], v232 offset:10240
    ds_read_b64_tr_b16 a[170:171], v233 offset:11264
    ds_read_b64_tr_b16 a[172:173], v234 offset:10240
    ds_read_b64_tr_b16 a[174:175], v235 offset:11264
    ds_read_b64_tr_b16 a[176:177], v232 offset:12288
    ds_read_b64_tr_b16 a[178:179], v233 offset:13312
    ds_read_b64_tr_b16 a[180:181], v234 offset:12288
    ds_read_b64_tr_b16 a[182:183], v235 offset:13312
    ds_read_b64_tr_b16 a[184:185], v232 offset:14336
    ds_read_b64_tr_b16 a[186:187], v233 offset:15360
    ds_read_b64_tr_b16 a[188:189], v234 offset:14336
    ds_read_b64_tr_b16 a[190:191], v235 offset:15360
    ds_read_b64_tr_b16 a[192:193], v232 offset:16384
    ds_read_b64_tr_b16 a[194:195], v233 offset:17408
    ds_read_b64_tr_b16 a[196:197], v234 offset:16384
    ds_read_b64_tr_b16 a[198:199], v235 offset:17408
    ds_read_b64_tr_b16 a[200:201], v232 offset:18432
    ds_read_b64_tr_b16 a[202:203], v233 offset:19456
    ds_read_b64_tr_b16 a[204:205], v234 offset:18432
    ds_read_b64_tr_b16 a[206:207], v235 offset:19456
    ds_read_b64_tr_b16 a[208:209], v232 offset:20480
    ds_read_b64_tr_b16 a[210:211], v233 offset:21504
    ds_read_b64_tr_b16 a[212:213], v234 offset:20480
    ds_read_b64_tr_b16 a[214:215], v235 offset:21504
    ds_read_b64_tr_b16 a[216:217], v232 offset:22528
    ds_read_b64_tr_b16 a[218:219], v233 offset:23552
    ds_read_b64_tr_b16 a[220:221], v234 offset:22528
    ds_read_b64_tr_b16 a[222:223], v235 offset:23552
    ds_read_b64_tr_b16 a[224:225], v232 offset:24576
    ds_read_b64_tr_b16 a[226:227], v233 offset:25600
    ds_read_b64_tr_b16 a[228:229], v234 offset:24576
    ds_read_b64_tr_b16 a[230:231], v235 offset:25600
    ds_read_b64_tr_b16 a[232:233], v232 offset:26624
    ds_read_b64_tr_b16 a[234:235], v233 offset:27648
    ds_read_b64_tr_b16 a[236:237], v234 offset:26624
    ds_read_b64_tr_b16 a[238:239], v235 offset:27648
    ds_read_b64_tr_b16 a[240:241], v232 offset:28672
    ds_read_b64_tr_b16 a[242:243], v233 offset:29696
    ds_read_b64_tr_b16 a[244:245], v234 offset:28672
    ds_read_b64_tr_b16 a[246:247], v235 offset:29696
    ds_read_b64_tr_b16 a[248:249], v232 offset:30720
    ds_read_b64_tr_b16 a[250:251], v233 offset:31744
    ds_read_b64_tr_b16 a[252:253], v234 offset:30720
    ds_read_b64_tr_b16 a[254:255], v235 offset:31744
    s_waitcnt lgkmcnt(0)
L_w3_9:
    s_waitcnt vmcnt(4)
    s_barrier
    ds_read_b64_tr_b16 v[192:193], v8 offset:0
    ds_read_b64_tr_b16 v[194:195], v8 offset:512
    ds_read_b64_tr_b16 v[196:197], v9 offset:0
    ds_read_b64_tr_b16 v[198:199], v9 offset:512
    ds_read_b64_tr_b16 v[200:201], v8 offset:2048
    ds_read_b64_tr_b16 v[202:203], v8 offset:2560
    ds_read_b64_tr_b16 v[204:205], v9 offset:2048
    ds_read_b64_tr_b16 v[206:207], v9 offset:2560
    ds_read_b64_tr_b16 v[208:209], v8 offset:4096
    ds_read_b64_tr_b16 v[210:211], v8 offset:4608
    ds_read_b64_tr_b16 v[212:213], v9 offset:4096
    ds_read_b64_tr_b16 v[214:215], v9 offset:4608
    s_waitcnt lgkmcnt(8)
    v_mfma_f32_32x32x16_bf16 v[128:143], a[0:3], v[192:195], 0
    ds_read_b64_tr_b16 v[216:217], v8 offset:6144
    ds_read_b64_tr_b16 v[218:219], v8 offset:6656
    s_add_u32 m0, s56, 32768
    v_mfma_f32_32x32x16_bf16 v[144:159], a[0:3], v[196:199], 0
    ds_read_b64_tr_b16 v[220:221], v9 offset:6144
    ds_read_b64_tr_b16 v[222:223], v9 offset:6656
    s_and_b32 s59, s59, 0x1fffff
    s_waitcnt lgkmcnt(8)
    v_mfma_f32_32x32x16_bf16 v[128:143], a[4:7], v[200:203], v[128:143]
    ds_read_b64_tr_b16 v[192:193], v8 offset:8192
    ds_read_b64_tr_b16 v[194:195], v8 offset:8704
    buffer_load_dwordx4 v56, s[8:11], s59 offen sc1 lds
    v_mfma_f32_32x32x16_bf16 v[144:159], a[4:7], v[204:207], v[144:159]
    ds_read_b64_tr_b16 v[196:197], v9 offset:8192
    ds_read_b64_tr_b16 v[198:199], v9 offset:8704
    buffer_load_dwordx4 v57, s[8:11], s59 offen offset:1024 sc1 lds
    s_waitcnt lgkmcnt(8)
    v_mfma_f32_32x32x16_bf16 v[128:143], a[8:11], v[208:211], v[128:143]
    ds_read_b64_tr_b16 v[200:201], v8 offset:10240
    ds_read_b64_tr_b16 v[202:203], v8 offset:10752
    s_add_u32 s59, s59, 262144
    v_mfma_f32_32x32x16_bf16 v[144:159], a[8:11], v[212:215], v[144:159]
    ds_read_b64_tr_b16 v[204:205], v9 offset:10240
    ds_read_b64_tr_b16 v[206:207], v9 offset:10752
    s_add_u32 m0, s56, 40960
    s_waitcnt lgkmcnt(8)
    v_mfma_f32_32x32x16_bf16 v[128:143], a[12:15], v[216:219], v[128:143]
    ds_read_b64_tr_b16 v[208:209], v8 offset:12288
    ds_read_b64_tr_b16 v[210:211], v8 offset:12800
    s_and_b32 s59, s59, 0x1fffff
    v_mfma_f32_32x32x16_bf16 v[144:159], a[12:15], v[220:223], v[144:159]
    ds_read_b64_tr_b16 v[212:213], v9 offset:12288
    ds_read_b64_tr_b16 v[214:215], v9 offset:12800
    buffer_load_dwordx4 v56, s[8:11], s59 offen sc1 lds
    s_waitcnt lgkmcnt(8)
    v_mfma_f32_32x32x16_bf16 v[128:143], a[16:19], v[192:195], v[128:143]
    ds_read_b64_tr_b16 v[216:217], v8 offset:14336
    ds_read_b64_tr_b16 v[218:219], v8 offset:14848
    buffer_load_dwordx4 v57, s[8:11], s59 offen offset:1024 sc1 lds
    v_mfma_f32_32x32x16_bf16 v[144:159], a[16:19], v[196:199], v[144:159]
    ds_read_b64_tr_b16 v[220:221], v9 offset:14336
    ds_read_b64_tr_b16 v[222:223], v9 offset:14848
    s_add_u32 s59, s59, 262144
    s_waitcnt vmcnt(4)
    s_barrier
    s_waitcnt lgkmcnt(8)
    v_mfma_f32_32x32x16_bf16 v[128:143], a[20:23], v[200:203], v[128:143]
    ds_read_b64_tr_b16 v[192:193], v8 offset:16384
    ds_read_b64_tr_b16 v[194:195], v8 offset:16896
    s_add_u32 m0, s56, 49152
    v_mfma_f32_32x32x16_bf16 v[144:159], a[20:23], v[204:207], v[144:159]
    ds_read_b64_tr_b16 v[196:197], v9 offset:16384
    ds_read_b64_tr_b16 v[198:199], v9 offset:16896
    s_and_b32 s59, s59, 0x1fffff
    s_waitcnt lgkmcnt(8)
    v_mfma_f32_32x32x16_bf16 v[128:143], a[24:27], v[208:211], v[128:143]
    ds_read_b64_tr_b16 v[200:201], v8 offset:18432
    ds_read_b64_tr_b16 v[202:203], v8 offset:18944
    buffer_load_dwordx4 v56, s[8:11], s59 offen sc1 lds
    v_mfma_f32_32x32x16_bf16 v[144:159], a[24:27], v[212:215], v[144:159]
    ds_read_b64_tr_b16 v[204:205], v9 offset:18432
    ds_read_b64_tr_b16 v[206:207], v9 offset:18944
    buffer_load_dwordx4 v57, s[8:11], s59 offen offset:1024 sc1 lds
    s_waitcnt lgkmcnt(8)
    v_mfma_f32_32x32x16_bf16 v[128:143], a[28:31], v[216:219], v[128:143]
    ds_read_b64_tr_b16 v[208:209], v8 offset:20480
    ds_read_b64_tr_b16 v[210:211], v8 offset:20992
    s_add_u32 s59, s59, 262144
    v_mfma_f32_32x32x16_bf16 v[144:159], a[28:31], v[220:223], v[144:159]
    ds_read_b64_tr_b16 v[212:213], v9 offset:20480
    ds_read_b64_tr_b16 v[214:215], v9 offset:20992
    s_add_u32 m0, s56, 57344
    s_waitcnt lgkmcnt(8)
    v_mfma_f32_32x32x16_bf16 v[128:143], a[32:35], v[192:195], v[128:143]
    ds_read_b64_tr_b16 v[216:217], v8 offset:22528
    ds_read_b64_tr_b16 v[218:219], v8 offset:23040
    s_and_b32 s59, s59, 0x1fffff
    v_mfma_f32_32x32x16_bf16 v[144:159], a[32:35], v[196:199], v[144:159]
    ds_read_b64_tr_b16 v[220:221], v9 offset:22528
    ds_read_b64_tr_b16 v[222:223], v9 offset:23040
    buffer_load_dwordx4 v56, s[8:11], s59 offen sc1 lds
    s_waitcnt lgkmcnt(8)
    v_mfma_f32_32x32x16_bf16 v[128:143], a[36:39], v[200:203], v[128:143]
    ds_read_b64_tr_b16 v[192:193], v8 offset:24576
    ds_read_b64_tr_b16 v[194:195], v8 offset:25088
    buffer_load_dwordx4 v57, s[8:11], s59 offen offset:1024 sc1 lds
    v_mfma_f32_32x32x16_bf16 v[144:159], a[36:39], v[204:207], v[144:159]
    ds_read_b64_tr_b16 v[196:197], v9 offset:24576
    ds_read_b64_tr_b16 v[198:199], v9 offset:25088
    s_add_u32 s59, s59, 262144
    s_waitcnt lgkmcnt(8)
    v_mfma_f32_32x32x16_bf16 v[128:143], a[40:43], v[208:211], v[128:143]
    ds_read_b64_tr_b16 v[200:201], v8 offset:26624
    ds_read_b64_tr_b16 v[202:203], v8 offset:27136
    s_add_u32 m0, s56, 65536
    v_mfma_f32_32x32x16_bf16 v[144:159], a[40:43], v[212:215], v[144:159]
    ds_read_b64_tr_b16 v[204:205], v9 offset:26624
    ds_read_b64_tr_b16 v[206:207], v9 offset:27136
    s_and_b32 s59, s59, 0x1fffff
    s_waitcnt lgkmcnt(8)
    v_mfma_f32_32x32x16_bf16 v[128:143], a[44:47], v[216:219], v[128:143]
    ds_read_b64_tr_b16 v[208:209], v8 offset:28672
    ds_read_b64_tr_b16 v[210:211], v8 offset:29184
    buffer_load_dwordx4 v60, s[8:11], s59 offen sc1 lds
    v_mfma_f32_32x32x16_bf16 v[144:159], a[44:47], v[220:223], v[144:159]
    ds_read_b64_tr_b16 v[212:213], v9 offset:28672
    ds_read_b64_tr_b16 v[214:215], v9 offset:29184
    buffer_load_dwordx4 v61, s[8:11], s59 offen offset:1024 sc1 lds
    s_waitcnt lgkmcnt(8)
    v_mfma_f32_32x32x16_bf16 v[128:143], a[48:51], v[192:195], v[128:143]
    ds_read_b64_tr_b16 v[216:217], v8 offset:30720
    ds_read_b64_tr_b16 v[218:219], v8 offset:31232
    s_add_u32 s59, s59, 262144
    v_mfma_f32_32x32x16_bf16 v[144:159], a[48:51], v[196:199], v[144:159]
    ds_read_b64_tr_b16 v[220:221], v9 offset:30720
    ds_read_b64_tr_b16 v[222:223], v9 offset:31232
    s_add_u32 m0, s56, 73728
    s_waitcnt vmcnt(2)
    s_barrier
    s_waitcnt lgkmcnt(8)
    v_mfma_f32_32x32x16_bf16 v[128:143], a[52:55], v[200:203], v[128:143]
    ds_read_b64_tr_b16 v[192:193], v8 offset:32768
    ds_read_b64_tr_b16 v[194:195], v8 offset:33280
    s_and_b32 s59, s59, 0x1fffff
    v_mfma_f32_32x32x16_bf16 v[144:159], a[52:55], v[204:207], v[144:159]
    ds_read_b64_tr_b16 v[196:197], v9 offset:32768
    ds_read_b64_tr_b16 v[198:199], v9 offset:33280
    buffer_load_dwordx4 v60, s[8:11], s59 offen sc1 lds
    s_waitcnt lgkmcnt(8)
    v_mfma_f32_32x32x16_bf16 v[128:143], a[56:59], v[208:211], v[128:143]
    ds_read_b64_tr_b16 v[200:201], v8 offset:34816
    ds_read_b64_tr_b16 v[202:203], v8 offset:35328
    buffer_load_dwordx4 v61, s[8:11], s59 offen offset:1024 sc1 lds
    v_mfma_f32_32x32x16_bf16 v[144:159], a[56:59], v[212:215], v[144:159]
    ds_read_b64_tr_b16 v[204:205], v9 offset:34816
    ds_read_b64_tr_b16 v[206:207], v9 offset:35328
    s_add_u32 s59, s59, 262144
    s_waitcnt lgkmcnt(8)
    v_mfma_f32_32x32x16_bf16 v[128:143], a[60:63], v[216:219], v[128:143]
    ds_read_b64_tr_b16 v[208:209], v8 offset:36864
    ds_read_b64_tr_b16 v[210:211], v8 offset:37376
    s_add_u32 m0, s56, 81920
    v_mfma_f32_32x32x16_bf16 v[144:159], a[60:63], v[220:223], v[144:159]
    ds_read_b64_tr_b16 v[212:213], v9 offset:36864
    ds_read_b64_tr_b16 v[214:215], v9 offset:37376
    s_and_b32 s59, s59, 0x1fffff
    s_waitcnt lgkmcnt(8)
    v_mfma_f32_32x32x16_bf16 v[128:143], a[64:67], v[192:195], v[128:143]
    ds_read_b64_tr_b16 v[216:217], v8 offset:38912
    ds_read_b64_tr_b16 v[218:219], v8 offset:39424
    buffer_load_dwordx4 v60, s[8:11], s59 offen sc1 lds
    v_mfma_f32_32x32x16_bf16 v[144:159], a[64:67], v[196:199], v[144:159]
    ds_read_b64_tr_b16 v[220:221], v9 offset:38912
    ds_read_b64_tr_b16 v[222:223], v9 offset:39424
    buffer_load_dwordx4 v61, s[8:11], s59 offen offset:1024 sc1 lds
    s_waitcnt lgkmcnt(8)
    v_mfma_f32_32x32x16_bf16 v[128:143], a[68:71], v[200:203], v[128:143]
    ds_read_b64_tr_b16 v[192:193], v8 offset:40960
    ds_read_b64_tr_b16 v[194:195], v8 offset:41472
    s_add_u32 s59, s59, 262144
    v_mfma_f32_32x32x16_bf16 v[144:159], a[68:71], v[204:207], v[144:159]
    ds_read_b64_tr_b16 v[196:197], v9 offset:40960
    ds_read_b64_tr_b16 v[198:199], v9 offset:41472
    s_add_u32 m0, s56, 90112
    s_waitcnt lgkmcnt(8)
    v_mfma_f32_32x32x16_bf16 v[128:143], a[72:75], v[208:211], v[128:143]
    ds_read_b64_tr_b16 v[200:201], v8 offset:43008
    ds_read_b64_tr_b16 v[202:203], v8 offset:43520
    s_and_b32 s59, s59, 0x1fffff
    v_mfma_f32_32x32x16_bf16 v[144:159], a[72:75], v[212:215], v[144:159]
    ds_read_b64_tr_b16 v[204:205], v9 offset:43008
    ds_read_b64_tr_b16 v[206:207], v9 offset:43520
    buffer_load_dwordx4 v60, s[8:11], s59 offen sc1 lds
    s_waitcnt lgkmcnt(8)
    v_mfma_f32_32x32x16_bf16 v[128:143], a[76:79], v[216:219], v[128:143]
    ds_read_b64_tr_b16 v[208:209], v8 offset:45056
    ds_read_b64_tr_b16 v[210:211], v8 offset:45568
    buffer_load_dwordx4 v61, s[8:11], s59 offen offset:1024 sc1 lds
    v_mfma_f32_32x32x16_bf16 v[144:159], a[76:79], v[220:223], v[144:159]
    ds_read_b64_tr_b16 v[212:213], v9 offset:45056
    ds_read_b64_tr_b16 v[214:215], v9 offset:45568
    s_add_u32 s59, s59, 262144
    s_waitcnt lgkmcnt(8)
    v_mfma_f32_32x32x16_bf16 v[128:143], a[80:83], v[192:195], v[128:143]
    ds_read_b64_tr_b16 v[216:217], v8 offset:47104
    ds_read_b64_tr_b16 v[218:219], v8 offset:47616
    s_add_u32 m0, s56, 98304
    v_mfma_f32_32x32x16_bf16 v[144:159], a[80:83], v[196:199], v[144:159]
    ds_read_b64_tr_b16 v[220:221], v9 offset:47104
    ds_read_b64_tr_b16 v[222:223], v9 offset:47616
    s_and_b32 s59, s59, 0x1fffff
    s_waitcnt lgkmcnt(8)
    v_mfma_f32_32x32x16_bf16 v[128:143], a[84:87], v[200:203], v[128:143]
    ds_read_b64_tr_b16 v[192:193], v8 offset:49152
    ds_read_b64_tr_b16 v[194:195], v8 offset:49664
    buffer_load_dwordx4 v60, s[8:11], s59 offen sc1 lds
    v_mfma_f32_32x32x16_bf16 v[144:159], a[84:87], v[204:207], v[144:159]
    ds_read_b64_tr_b16 v[196:197], v9 offset:49152
    ds_read_b64_tr_b16 v[198:199], v9 offset:49664
    buffer_load_dwordx4 v61, s[8:11], s59 offen offset:1024 sc1 lds
    s_waitcnt lgkmcnt(8)
    v_mfma_f32_32x32x16_bf16 v[128:143], a[88:91], v[208:211], v[128:143]
    ds_read_b64_tr_b16 v[200:201], v8 offset:51200
    ds_read_b64_tr_b16 v[202:203], v8 offset:51712
    s_add_u32 s59, s59, 262144
    v_mfma_f32_32x32x16_bf16 v[144:159], a[88:91], v[212:215], v[144:159]
    ds_read_b64_tr_b16 v[204:205], v9 offset:51200
    ds_read_b64_tr_b16 v[206:207], v9 offset:51712
    s_add_u32 m0, s56, 106496
    s_waitcnt lgkmcnt(8)
    v_mfma_f32_32x32x16_bf16 v[128:143], a[92:95], v[216:219], v[128:143]
    ds_read_b64_tr_b16 v[208:209], v8 offset:53248
    ds_read_b64_tr_b16 v[210:211], v8 offset:53760
    s_and_b32 s59, s59, 0x1fffff
    v_mfma_f32_32x32x16_bf16 v[144:159], a[92:95], v[220:223], v[144:159]
    ds_read_b64_tr_b16 v[212:213], v9 offset:53248
    ds_read_b64_tr_b16 v[214:215], v9 offset:53760
    buffer_load_dwordx4 v60, s[8:11], s59 offen sc1 lds
    s_waitcnt lgkmcnt(8)
    v_mfma_f32_32x32x16_bf16 v[128:143], a[96:99], v[192:195], v[128:143]
    ds_read_b64_tr_b16 v[216:217], v8 offset:55296
    ds_read_b64_tr_b16 v[218:219], v8 offset:55808
    buffer_load_dwordx4 v61, s[8:11], s59 offen offset:1024 sc1 lds
    v_mfma_f32_32x32x16_bf16 v[144:159], a[96:99], v[196:199], v[144:159]
    ds_read_b64_tr_b16 v[220:221], v9 offset:55296
    ds_read_b64_tr_b16 v[222:223], v9 offset:55808
    s_add_u32 s59, s59, 262144
    s_waitcnt lgkmcnt(8)
    v_mfma_f32_32x32x16_bf16 v[128:143], a[100:103], v[200:203], v[128:143]
    ds_read_b64_tr_b16 v[192:193], v8 offset:57344
    ds_read_b64_tr_b16 v[194:195], v8 offset:57856
    s_add_u32 m0, s56, 114688
    v_mfma_f32_32x32x16_bf16 v[144:159], a[100:103], v[204:207], v[144:159]
    ds_read_b64_tr_b16 v[196:197], v9 offset:57344
    ds_read_b64_tr_b16 v[198:199], v9 offset:57856
    s_and_b32 s59, s59, 0x1fffff
    s_waitcnt lgkmcnt(8)
    v_mfma_f32_32x32x16_bf16 v[128:143], a[104:107], v[208:211], v[128:143]
    ds_read_b64_tr_b16 v[200:201], v8 offset:59392
    ds_read_b64_tr_b16 v[202:203], v8 offset:59904
    buffer_load_dwordx4 v60, s[8:11], s59 offen sc1 lds
    v_mfma_f32_32x32x16_bf16 v[144:159], a[104:107], v[212:215], v[144:159]
    ds_read_b64_tr_b16 v[204:205], v9 offset:59392
    ds_read_b64_tr_b16 v[206:207], v9 offset:59904
    buffer_load_dwordx4 v61, s[8:11], s59 offen offset:1024 sc1 lds
    s_waitcnt lgkmcnt(8)
    v_mfma_f32_32x32x16_bf16 v[128:143], a[108:111], v[216:219], v[128:143]
    ds_read_b64_tr_b16 v[208:209], v8 offset:61440
    ds_read_b64_tr_b16 v[210:211], v8 offset:61952
    s_add_u32 s59, s59, 262144
    v_mfma_f32_32x32x16_bf16 v[144:159], a[108:111], v[220:223], v[144:159]
    ds_read_b64_tr_b16 v[212:213], v9 offset:61440
    ds_read_b64_tr_b16 v[214:215], v9 offset:61952
    s_add_u32 m0, s56, 122880
    s_waitcnt lgkmcnt(8)
    v_mfma_f32_32x32x16_bf16 v[128:143], a[112:115], v[192:195], v[128:143]
    ds_read_b64_tr_b16 v[216:217], v8 offset:63488
    ds_read_b64_tr_b16 v[218:219], v8 offset:64000
    s_and_b32 s59, s59, 0x1fffff
    v_mfma_f32_32x32x16_bf16 v[144:159], a[112:115], v[196:199], v[144:159]
    ds_read_b64_tr_b16 v[220:221], v9 offset:63488
    ds_read_b64_tr_b16 v[222:223], v9 offset:64000
    buffer_load_dwordx4 v60, s[8:11], s59 offen sc1 lds
    s_waitcnt vmcnt(11)
    s_barrier
    s_waitcnt lgkmcnt(8)
    v_mfma_f32_32x32x16_bf16 v[128:143], a[116:119], v[200:203], v[128:143]
    ds_read_b64_tr_b16 v[192:193], v10 offset:0
    ds_read_b64_tr_b16 v[194:195], v10 offset:512
    buffer_load_dwordx4 v61, s[8:11], s59 offen offset:1024 sc1 lds
    v_mfma_f32_32x32x16_bf16 v[144:159], a[116:119], v[204:207], v[144:159]
    ds_read_b64_tr_b16 v[196:197], v11 offset:0
    ds_read_b64_tr_b16 v[198:199], v11 offset:512
    s_add_u32 s59, s59, 262144
    s_waitcnt lgkmcnt(8)
    v_mfma_f32_32x32x16_bf16 v[128:143], a[120:123], v[208:211], v[128:143]
    ds_read_b64_tr_b16 v[200:201], v10 offset:2048
    ds_read_b64_tr_b16 v[202:203], v10 offset:2560
    s_lshl_b32 s66, s93, 18
    v_mfma_f32_32x32x16_bf16 v[144:159], a[120:123], v[212:215], v[144:159]
    ds_read_b64_tr_b16 v[204:205], v11 offset:2048
    ds_read_b64_tr_b16 v[206:207], v11 offset:2560
    s_lshl_b32 s67, s3, 16
    s_waitcnt lgkmcnt(8)
    v_mfma_f32_32x32x16_bf16 v[128:143], a[124:127], v[216:219], v[128:143]
    ds_read_b64_tr_b16 v[208:209], v10 offset:4096
    ds_read_b64_tr_b16 v[210:211], v10 offset:4608
    s_add_u32 s66, s66, s67
    v_mfma_f32_32x32x16_bf16 v[144:159], a[124:127], v[220:223], v[144:159]
    ds_read_b64_tr_b16 v[212:213], v11 offset:4096
    ds_read_b64_tr_b16 v[214:215], v11 offset:4608
    s_lshl_b32 s67, s0, 6
    v_add_u32 v232, s89, v246
    v_add_u32 v233, s89, v247
    v_add_u32 v234, s89, v248
    v_add_u32 v235, s89, v249
    s_waitcnt lgkmcnt(8)
    v_mfma_f32_32x32x16_bf16 v[160:175], a[0:3], v[192:195], 0
    ds_read_b64_tr_b16 v[216:217], v10 offset:6144
    ds_read_b64_tr_b16 v[218:219], v10 offset:6656
    s_add_u32 s66, s66, s67
    s_add_u32 m0, s56, 131072
    v_mfma_f32_32x32x16_bf16 v[176:191], a[0:3], v[196:199], 0
    ds_read_b64_tr_b16 v[220:221], v11 offset:6144
    ds_read_b64_tr_b16 v[222:223], v11 offset:6656
    s_add_u32 s66, s66, 4194304
    buffer_load_dwordx4 v58, s[36:39], s66 offen sc1 lds
    s_waitcnt lgkmcnt(8)
    v_mfma_f32_32x32x16_bf16 v[160:175], a[4:7], v[200:203], v[160:175]
    ds_read_b64_tr_b16 v[192:193], v10 offset:8192
    ds_read_b64_tr_b16 v[194:195], v10 offset:8704
    buffer_load_dwordx4 v[104:107], v18, s[36:39], s61 offen offset:0 sc1
    buffer_load_dwordx4 v59, s[36:39], s66 offen offset:1024 sc1 lds
    v_mfma_f32_32x32x16_bf16 v[176:191], a[4:7], v[204:207], v[176:191]
    ds_read_b64_tr_b16 v[196:197], v11 offset:8192
    ds_read_b64_tr_b16 v[198:199], v11 offset:8704
    s_waitcnt lgkmcnt(8)
    v_mfma_f32_32x32x16_bf16 v[160:175], a[8:11], v[208:211], v[160:175]
    ds_read_b64_tr_b16 v[200:201], v10 offset:10240
    ds_read_b64_tr_b16 v[202:203], v10 offset:10752
    v_mfma_f32_32x32x16_bf16 v[176:191], a[8:11], v[212:215], v[176:191]
    ds_read_b64_tr_b16 v[204:205], v11 offset:10240
    ds_read_b64_tr_b16 v[206:207], v11 offset:10752
    s_waitcnt lgkmcnt(8)
    v_mfma_f32_32x32x16_bf16 v[160:175], a[12:15], v[216:219], v[160:175]
    ds_read_b64_tr_b16 v[208:209], v10 offset:12288
    ds_read_b64_tr_b16 v[210:211], v10 offset:12800
    v_mfma_f32_32x32x16_bf16 v[176:191], a[12:15], v[220:223], v[176:191]
    ds_read_b64_tr_b16 v[212:213], v11 offset:12288
    ds_read_b64_tr_b16 v[214:215], v11 offset:12800
    s_waitcnt lgkmcnt(8)
    v_mfma_f32_32x32x16_bf16 v[160:175], a[16:19], v[192:195], v[160:175]
    ds_read_b64_tr_b16 v[216:217], v10 offset:14336
    ds_read_b64_tr_b16 v[218:219], v10 offset:14848
    v_mfma_f32_32x32x16_bf16 v[176:191], a[16:19], v[196:199], v[176:191]
    ds_read_b64_tr_b16 v[220:221], v11 offset:14336
    ds_read_b64_tr_b16 v[222:223], v11 offset:14848
    s_waitcnt vmcnt(11)
    s_barrier
    s_waitcnt lgkmcnt(8)
    v_mfma_f32_32x32x16_bf16 v[160:175], a[20:23], v[200:203], v[160:175]
    ds_read_b64_tr_b16 v[192:193], v10 offset:16384
    ds_read_b64_tr_b16 v[194:195], v10 offset:16896
    v_mfma_f32_32x32x16_bf16 v[176:191], a[20:23], v[204:207], v[176:191]
    ds_read_b64_tr_b16 v[196:197], v11 offset:16384
    ds_read_b64_tr_b16 v[198:199], v11 offset:16896
    s_waitcnt lgkmcnt(8)
    v_mfma_f32_32x32x16_bf16 v[160:175], a[24:27], v[208:211], v[160:175]
    ds_read_b64_tr_b16 v[200:201], v10 offset:18432
    ds_read_b64_tr_b16 v[202:203], v10 offset:18944
    v_mfma_f32_32x32x16_bf16 v[176:191], a[24:27], v[212:215], v[176:191]
    ds_read_b64_tr_b16 v[204:205], v11 offset:18432
    ds_read_b64_tr_b16 v[206:207], v11 offset:18944
    s_waitcnt lgkmcnt(8)
    v_mfma_f32_32x32x16_bf16 v[160:175], a[28:31], v[216:219], v[160:175]
    ds_read_b64_tr_b16 v[208:209], v10 offset:20480
    ds_read_b64_tr_b16 v[210:211], v10 offset:20992
    v_mfma_f32_32x32x16_bf16 v[176:191], a[28:31], v[220:223], v[176:191]
    ds_read_b64_tr_b16 v[212:213], v11 offset:20480
    ds_read_b64_tr_b16 v[214:215], v11 offset:20992
    s_waitcnt lgkmcnt(8)
    v_mfma_f32_32x32x16_bf16 v[160:175], a[32:35], v[192:195], v[160:175]
    ds_read_b64_tr_b16 v[216:217], v10 offset:22528
    ds_read_b64_tr_b16 v[218:219], v10 offset:23040
    v_mfma_f32_32x32x16_bf16 v[176:191], a[32:35], v[196:199], v[176:191]
    ds_read_b64_tr_b16 v[220:221], v11 offset:22528
    ds_read_b64_tr_b16 v[222:223], v11 offset:23040
    s_mov_b32 s97, 0x80000
L_rc10:
    s_waitcnt vmcnt(1)
    v_and_b32 v20, v105, v107
    v_cmp_ne_u32 vcc, 1, v20
    s_cbranch_vccz L_rcx10
    s_sleep 1
    buffer_load_dwordx4 v[104:107], v18, s[36:39], s61 offen offset:0 sc1
    s_sub_u32 s97, s97, 1
    s_waitcnt vmcnt(0)
    s_cbranch_scc0 L_rc10
L_rcx10:
    v_mov_b32 v96, v104
    v_mov_b32 v98, v104
    v_mov_b32 v97, v106
    v_mov_b32 v99, v106
    v_permlane32_swap_b32 v96, v98
    s_nop 0
    v_permlane32_swap_b32 v97, v99
    v_pk_fma_f32 v[48:49], v[64:65], v[96:97], v[80:81] op_sel:[0,1,0] op_sel_hi:[1,1,1]
    v_pk_fma_f32 v[50:51], v[66:67], v[96:97], v[82:83] op_sel:[0,1,0] op_sel_hi:[1,1,1]
    v_pk_fma_f32 v[128:129], v[128:129], v[96:97], v[48:49] op_sel:[0,0,0] op_sel_hi:[1,0,1]
    v_pk_fma_f32 v[130:131], v[130:131], v[96:97], v[50:51] op_sel:[0,0,0] op_sel_hi:[1,0,1]
    v_exp_f32 v48, v128
    v_exp_f32 v49, v129
    v_exp_f32 v50, v130
    v_exp_f32 v51, v131
    v_pk_add_f32 v[48:49], v[48:49], 1.0 op_sel_hi:[1,0]
    v_pk_add_f32 v[50:51], v[50:51], 1.0 op_sel_hi:[1,0]
    v_rcp_f32 v48, v48
    v_rcp_f32 v49, v49
    v_rcp_f32 v50, v50
    v_rcp_f32 v51, v51
    v_pk_mul_f32 v[48:49], v[48:49], v[128:129]
    v_pk_mul_f32 v[50:51], v[50:51], v[130:131]
    v_cvt_pk_bf16_f32 v24, v48, v49
    v_cvt_pk_bf16_f32 v25, v50, v51
    v_pk_fma_f32 v[48:49], v[68:69], v[96:97], v[84:85] op_sel:[0,1,0] op_sel_hi:[1,1,1]
    v_pk_fma_f32 v[50:51], v[70:71], v[96:97], v[86:87] op_sel:[0,1,0] op_sel_hi:[1,1,1]
    v_pk_fma_f32 v[132:133], v[132:133], v[96:97], v[48:49] op_sel:[0,0,0] op_sel_hi:[1,0,1]
    v_pk_fma_f32 v[134:135], v[134:135], v[96:97], v[50:51] op_sel:[0,0,0] op_sel_hi:[1,0,1]
    v_exp_f32 v48, v132
    v_exp_f32 v49, v133
    v_exp_f32 v50, v134
    v_exp_f32 v51, v135
    v_pk_add_f32 v[48:49], v[48:49], 1.0 op_sel_hi:[1,0]
    v_pk_add_f32 v[50:51], v[50:51], 1.0 op_sel_hi:[1,0]
    v_rcp_f32 v48, v48
    v_rcp_f32 v49, v49
    v_rcp_f32 v50, v50
    v_rcp_f32 v51, v51
    v_pk_mul_f32 v[48:49], v[48:49], v[132:133]
    v_pk_mul_f32 v[50:51], v[50:51], v[134:135]
    v_cvt_pk_bf16_f32 v26, v48, v49
    v_cvt_pk_bf16_f32 v27, v50, v51
    v_pk_fma_f32 v[48:49], v[72:73], v[96:97], v[88:89] op_sel:[0,1,0] op_sel_hi:[1,1,1]
    v_pk_fma_f32 v[50:51], v[74:75], v[96:97], v[90:91] op_sel:[0,1,0] op_sel_hi:[1,1,1]
    v_pk_fma_f32 v[136:137], v[136:137], v[96:97], v[48:49] op_sel:[0,0,0] op_sel_hi:[1,0,1]
    v_pk_fma_f32 v[138:139], v[138:139], v[96:97], v[50:51] op_sel:[0,0,0] op_sel_hi:[1,0,1]
    v_exp_f32 v48, v136
    v_exp_f32 v49, v137
    v_exp_f32 v50, v138
    v_exp_f32 v51, v139
    v_pk_add_f32 v[48:49], v[48:49], 1.0 op_sel_hi:[1,0]
    v_pk_add_f32 v[50:51], v[50:51], 1.0 op_sel_hi:[1,0]
    v_rcp_f32 v48, v48
    v_rcp_f32 v49, v49
    v_rcp_f32 v50, v50
    v_rcp_f32 v51, v51
    v_pk_mul_f32 v[48:49], v[48:49], v[136:137]
    v_pk_mul_f32 v[50:51], v[50:51], v[138:139]
    v_cvt_pk_bf16_f32 v28, v48, v49
    v_cvt_pk_bf16_f32 v29, v50, v51
    v_pk_fma_f32 v[48:49], v[76:77], v[96:97], v[92:93] op_sel:[0,1,0] op_sel_hi:[1,1,1]
    v_pk_fma_f32 v[50:51], v[78:79], v[96:97], v[94:95] op_sel:[0,1,0] op_sel_hi:[1,1,1]
    v_pk_fma_f32 v[140:141], v[140:141], v[96:97], v[48:49] op_sel:[0,0,0] op_sel_hi:[1,0,1]
    v_pk_fma_f32 v[142:143], v[142:143], v[96:97], v[50:51] op_sel:[0,0,0] op_sel_hi:[1,0,1]
    v_exp_f32 v48, v140
    v_exp_f32 v49, v141
    v_exp_f32 v50, v142
    v_exp_f32 v51, v143
    v_pk_add_f32 v[48:49], v[48:49], 1.0 op_sel_hi:[1,0]
    v_pk_add_f32 v[50:51], v[50:51], 1.0 op_sel_hi:[1,0]
    v_rcp_f32 v48, v48
    v_rcp_f32 v49, v49
    v_rcp_f32 v50, v50
    v_rcp_f32 v51, v51
    v_pk_mul_f32 v[48:49], v[48:49], v[140:141]
    v_pk_mul_f32 v[50:51], v[50:51], v[142:143]
    v_cvt_pk_bf16_f32 v30, v48, v49
    v_cvt_pk_bf16_f32 v31, v50, v51
    s_add_u32 s58, s57, 0
    buffer_store_dwordx4 v[24:27], v18, s[36:39], s58 offen offset:0 sc1
    buffer_store_dwordx4 v[28:31], v18, s[36:39], s58 offen offset:1024 sc1
    v_pk_fma_f32 v[48:49], v[64:65], v[98:99], v[80:81] op_sel:[0,1,0] op_sel_hi:[1,1,1]
    v_pk_fma_f32 v[50:51], v[66:67], v[98:99], v[82:83] op_sel:[0,1,0] op_sel_hi:[1,1,1]
    v_pk_fma_f32 v[144:145], v[144:145], v[98:99], v[48:49] op_sel:[0,0,0] op_sel_hi:[1,0,1]
    v_pk_fma_f32 v[146:147], v[146:147], v[98:99], v[50:51] op_sel:[0,0,0] op_sel_hi:[1,0,1]
    v_exp_f32 v48, v144
    v_exp_f32 v49, v145
    v_exp_f32 v50, v146
    v_exp_f32 v51, v147
    v_pk_add_f32 v[48:49], v[48:49], 1.0 op_sel_hi:[1,0]
    v_pk_add_f32 v[50:51], v[50:51], 1.0 op_sel_hi:[1,0]
    v_rcp_f32 v48, v48
    v_rcp_f32 v49, v49
    v_rcp_f32 v50, v50
    v_rcp_f32 v51, v51
    v_pk_mul_f32 v[48:49], v[48:49], v[144:145]
    v_pk_mul_f32 v[50:51], v[50:51], v[146:147]
    v_cvt_pk_bf16_f32 v32, v48, v49
    v_cvt_pk_bf16_f32 v33, v50, v51
    v_pk_fma_f32 v[48:49], v[68:69], v[98:99], v[84:85] op_sel:[0,1,0] op_sel_hi:[1,1,1]
    v_pk_fma_f32 v[50:51], v[70:71], v[98:99], v[86:87] op_sel:[0,1,0] op_sel_hi:[1,1,1]
    v_pk_fma_f32 v[148:149], v[148:149], v[98:99], v[48:49] op_sel:[0,0,0] op_sel_hi:[1,0,1]
    v_pk_fma_f32 v[150:151], v[150:151], v[98:99], v[50:51] op_sel:[0,0,0] op_sel_hi:[1,0,1]
    v_exp_f32 v48, v148
    v_exp_f32 v49, v149
    v_exp_f32 v50, v150
    v_exp_f32 v51, v151
    v_pk_add_f32 v[48:49], v[48:49], 1.0 op_sel_hi:[1,0]
    v_pk_add_f32 v[50:51], v[50:51], 1.0 op_sel_hi:[1,0]
    v_rcp_f32 v48, v48
    v_rcp_f32 v49, v49
    v_rcp_f32 v50, v50
    v_rcp_f32 v51, v51
    v_pk_mul_f32 v[48:49], v[48:49], v[148:149]
    v_pk_mul_f32 v[50:51], v[50:51], v[150:151]
    v_cvt_pk_bf16_f32 v34, v48, v49
    v_cvt_pk_bf16_f32 v35, v50, v51
    v_pk_fma_f32 v[48:49], v[72:73], v[98:99], v[88:89] op_sel:[0,1,0] op_sel_hi:[1,1,1]
    v_pk_fma_f32 v[50:51], v[74:75], v[98:99], v[90:91] op_sel:[0,1,0] op_sel_hi:[1,1,1]
    v_pk_fma_f32 v[152:153], v[152:153], v[98:99], v[48:49] op_sel:[0,0,0] op_sel_hi:[1,0,1]
    v_pk_fma_f32 v[154:155], v[154:155], v[98:99], v[50:51] op_sel:[0,0,0] op_sel_hi:[1,0,1]
    v_exp_f32 v48, v152
    v_exp_f32 v49, v153
    v_exp_f32 v50, v154
    v_exp_f32 v51, v155
    v_pk_add_f32 v[48:49], v[48:49], 1.0 op_sel_hi:[1,0]
    v_pk_add_f32 v[50:51], v[50:51], 1.0 op_sel_hi:[1,0]
    v_rcp_f32 v48, v48
    v_rcp_f32 v49, v49
    v_rcp_f32 v50, v50
    v_rcp_f32 v51, v51
    v_pk_mul_f32 v[48:49], v[48:49], v[152:153]
    v_pk_mul_f32 v[50:51], v[50:51], v[154:155]
    v_cvt_pk_bf16_f32 v36, v48, v49
    v_cvt_pk_bf16_f32 v37, v50, v51
    v_pk_fma_f32 v[48:49], v[76:77], v[98:99], v[92:93] op_sel:[0,1,0] op_sel_hi:[1,1,1]
    v_pk_fma_f32 v[50:51], v[78:79], v[98:99], v[94:95] op_sel:[0,1,0] op_sel_hi:[1,1,1]
    v_pk_fma_f32 v[156:157], v[156:157], v[98:99], v[48:49] op_sel:[0,0,0] op_sel_hi:[1,0,1]
    v_pk_fma_f32 v[158:159], v[158:159], v[98:99], v[50:51] op_sel:[0,0,0] op_sel_hi:[1,0,1]
    v_exp_f32 v48, v156
    v_exp_f32 v49, v157
    v_exp_f32 v50, v158
    v_exp_f32 v51, v159
    v_pk_add_f32 v[48:49], v[48:49], 1.0 op_sel_hi:[1,0]
    v_pk_add_f32 v[50:51], v[50:51], 1.0 op_sel_hi:[1,0]
    v_rcp_f32 v48, v48
    v_rcp_f32 v49, v49
    v_rcp_f32 v50, v50
    v_rcp_f32 v51, v51
    v_pk_mul_f32 v[48:49], v[48:49], v[156:157]
    v_pk_mul_f32 v[50:51], v[50:51], v[158:159]
    v_cvt_pk_bf16_f32 v38, v48, v49
    v_cvt_pk_bf16_f32 v39, v50, v51
    s_add_u32 s58, s57, 114688
    buffer_store_dwordx4 v[32:35], v18, s[36:39], s58 offen offset:0 sc1
    buffer_store_dwordx4 v[36:39], v18, s[36:39], s58 offen offset:1024 sc1
    s_waitcnt lgkmcnt(8)
    v_mfma_f32_32x32x16_bf16 v[160:175], a[36:39], v[200:203], v[160:175]
    ds_read_b64_tr_b16 v[192:193], v10 offset:24576
    ds_read_b64_tr_b16 v[194:195], v10 offset:25088
    s_add_u32 s98, s91, 4
    v_mfma_f32_32x32x16_bf16 v[176:191], a[36:39], v[204:207], v[176:191]
    ds_read_b64_tr_b16 v[196:197], v11 offset:24576
    ds_read_b64_tr_b16 v[198:199], v11 offset:25088
    s_add_u32 m0, s89, 0
    s_waitcnt lgkmcnt(8)
    v_mfma_f32_32x32x16_bf16 v[160:175], a[40:43], v[208:211], v[160:175]
    ds_read_b64_tr_b16 v[200:201], v10 offset:26624
    ds_read_b64_tr_b16 v[202:203], v10 offset:27136
    s_cmp_ge_u32 s98, 7
    s_cselect_b32 s86, 7, 0
    v_mfma_f32_32x32x16_bf16 v[176:191], a[40:43], v[212:215], v[176:191]
    ds_read_b64_tr_b16 v[204:205], v11 offset:26624
    ds_read_b64_tr_b16 v[206:207], v11 offset:27136
    s_sub_u32 s98, s98, s86
    s_waitcnt lgkmcnt(8)
    v_mfma_f32_32x32x16_bf16 v[160:175], a[44:47], v[216:219], v[160:175]
    ds_read_b64_tr_b16 v[208:209], v10 offset:28672
    ds_read_b64_tr_b16 v[210:211], v10 offset:29184
    s_lshl_b32 s86, s98, 16
    v_mfma_f32_32x32x16_bf16 v[176:191], a[44:47], v[220:223], v[176:191]
    ds_read_b64_tr_b16 v[212:213], v11 offset:28672
    ds_read_b64_tr_b16 v[214:215], v11 offset:29184
    s_add_u32 s86, s86, s90
    s_waitcnt lgkmcnt(8)
    v_mfma_f32_32x32x16_bf16 v[160:175], a[48:51], v[192:195], v[160:175]
    ds_read_b64_tr_b16 v[216:217], v10 offset:30720
    ds_read_b64_tr_b16 v[218:219], v10 offset:31232
    buffer_load_dwordx4 v228, s[24:27], s86 offen offset:0 lds
    v_mfma_f32_32x32x16_bf16 v[176:191], a[48:51], v[196:199], v[176:191]
    ds_read_b64_tr_b16 v[220:221], v11 offset:30720
    ds_read_b64_tr_b16 v[222:223], v11 offset:31232
    buffer_load_dwordx4 v229, s[24:27], s86 offen offset:1024 lds
    s_waitcnt vmcnt(6)
    s_barrier
    s_waitcnt lgkmcnt(8)
    v_mfma_f32_32x32x16_bf16 v[160:175], a[52:55], v[200:203], v[160:175]
    ds_read_b64_tr_b16 v[192:193], v10 offset:32768
    ds_read_b64_tr_b16 v[194:195], v10 offset:33280
    buffer_load_dwordx4 v230, s[24:27], s86 offen offset:2048 lds
    v_mfma_f32_32x32x16_bf16 v[176:191], a[52:55], v[204:207], v[176:191]
    ds_read_b64_tr_b16 v[196:197], v11 offset:32768
    ds_read_b64_tr_b16 v[198:199], v11 offset:33280
    buffer_load_dwordx4 v231, s[24:27], s86 offen offset:3072 lds
    s_waitcnt lgkmcnt(8)
    v_mfma_f32_32x32x16_bf16 v[160:175], a[56:59], v[208:211], v[160:175]
    ds_read_b64_tr_b16 v[200:201], v10 offset:34816
    ds_read_b64_tr_b16 v[202:203], v10 offset:35328
    s_add_u32 m0, m0, 4096
    v_mfma_f32_32x32x16_bf16 v[176:191], a[56:59], v[212:215], v[176:191]
    ds_read_b64_tr_b16 v[204:205], v11 offset:34816
    ds_read_b64_tr_b16 v[206:207], v11 offset:35328
    s_add_u32 s86, s86, 32768
    s_waitcnt lgkmcnt(8)
    v_mfma_f32_32x32x16_bf16 v[160:175], a[60:63], v[216:219], v[160:175]
    ds_read_b64_tr_b16 v[208:209], v10 offset:36864
    ds_read_b64_tr_b16 v[210:211], v10 offset:37376
    buffer_load_dwordx4 v228, s[24:27], s86 offen offset:0 lds
    v_mfma_f32_32x32x16_bf16 v[176:191], a[60:63], v[220:223], v[176:191]
    ds_read_b64_tr_b16 v[212:213], v11 offset:36864
    ds_read_b64_tr_b16 v[214:215], v11 offset:37376
    buffer_load_dwordx4 v229, s[24:27], s86 offen offset:1024 lds
    s_waitcnt lgkmcnt(8)
    v_mfma_f32_32x32x16_bf16 v[160:175], a[64:67], v[192:195], v[160:175]
    ds_read_b64_tr_b16 v[216:217], v10 offset:38912
    ds_read_b64_tr_b16 v[218:219], v10 offset:39424
    buffer_load_dwordx4 v230, s[24:27], s86 offen offset:2048 lds
    v_mfma_f32_32x32x16_bf16 v[176:191], a[64:67], v[196:199], v[176:191]
    ds_read_b64_tr_b16 v[220:221], v11 offset:38912
    ds_read_b64_tr_b16 v[222:223], v11 offset:39424
    buffer_load_dwordx4 v231, s[24:27], s86 offen offset:3072 lds
    s_waitcnt lgkmcnt(8)
    v_mfma_f32_32x32x16_bf16 v[160:175], a[68:71], v[200:203], v[160:175]
    ds_read_b64_tr_b16 v[192:193], v10 offset:40960
    ds_read_b64_tr_b16 v[194:195], v10 offset:41472
    s_add_u32 s98, s91, 5
    v_mfma_f32_32x32x16_bf16 v[176:191], a[68:71], v[204:207], v[176:191]
    ds_read_b64_tr_b16 v[196:197], v11 offset:40960
    ds_read_b64_tr_b16 v[198:199], v11 offset:41472
    s_add_u32 m0, s89, 8192
    s_waitcnt lgkmcnt(8)
    v_mfma_f32_32x32x16_bf16 v[160:175], a[72:75], v[208:211], v[160:175]
    ds_read_b64_tr_b16 v[200:201], v10 offset:43008
    ds_read_b64_tr_b16 v[202:203], v10 offset:43520
    buffer_load_dwordx4 v[108:111], v18, s[36:39], s61 offen offset:1024 sc1
    s_cmp_ge_u32 s98, 7
    s_cselect_b32 s86, 7, 0
    v_mfma_f32_32x32x16_bf16 v[176:191], a[72:75], v[212:215], v[176:191]
    ds_read_b64_tr_b16 v[204:205], v11 offset:43008
    ds_read_b64_tr_b16 v[206:207], v11 offset:43520
    s_sub_u32 s98, s98, s86
    s_waitcnt lgkmcnt(8)
    v_mfma_f32_32x32x16_bf16 v[160:175], a[76:79], v[216:219], v[160:175]
    ds_read_b64_tr_b16 v[208:209], v10 offset:45056
    ds_read_b64_tr_b16 v[210:211], v10 offset:45568
    s_lshl_b32 s86, s98, 16
    v_mfma_f32_32x32x16_bf16 v[176:191], a[76:79], v[220:223], v[176:191]
    ds_read_b64_tr_b16 v[212:213], v11 offset:45056
    ds_read_b64_tr_b16 v[214:215], v11 offset:45568
    s_add_u32 s86, s86, s90
    s_waitcnt lgkmcnt(8)
    v_mfma_f32_32x32x16_bf16 v[160:175], a[80:83], v[192:195], v[160:175]
    ds_read_b64_tr_b16 v[216:217], v10 offset:47104
    ds_read_b64_tr_b16 v[218:219], v10 offset:47616
    buffer_load_dwordx4 v228, s[24:27], s86 offen offset:0 lds
    v_mfma_f32_32x32x16_bf16 v[176:191], a[80:83], v[196:199], v[176:191]
    ds_read_b64_tr_b16 v[220:221], v11 offset:47104
    ds_read_b64_tr_b16 v[222:223], v11 offset:47616
    buffer_load_dwordx4 v229, s[24:27], s86 offen offset:1024 lds
    s_waitcnt vmcnt(11)
    s_barrier
    s_cmp_eq_u32 s3, 3
    s_cbranch_scc0 L_w3_11
    s_lshl_b32 s87, s1, 7
    s_add_u32 s87, s87, 17989632
    s_mov_b64 exec, 1
    v_mov_b32 v252, 0
    v_mov_b32 v253, 1
    buffer_store_dword v253, v252, s[36:39], s87 offen sc1
    s_mov_b64 exec, -1
L_w3_11:
    s_waitcnt lgkmcnt(8)
    v_mfma_f32_32x32x16_bf16 v[160:175], a[84:87], v[200:203], v[160:175]
    ds_read_b64_tr_b16 v[192:193], v10 offset:49152
    ds_read_b64_tr_b16 v[194:195], v10 offset:49664
    buffer_load_dwordx4 v230, s[24:27], s86 offen offset:2048 lds
    v_mfma_f32_32x32x16_bf16 v[176:191], a[84:87], v[204:207], v[176:191]
    ds_read_b64_tr_b16 v[196:197], v11 offset:49152
    ds_read_b64_tr_b16 v[198:199], v11 offset:49664
    buffer_load_dwordx4 v231, s[24:27], s86 offen offset:3072 lds
    s_waitcnt lgkmcnt(8)
    v_mfma_f32_32x32x16_bf16 v[160:175], a[88:91], v[208:211], v[160:175]
    ds_read_b64_tr_b16 v[200:201], v10 offset:51200
    ds_read_b64_tr_b16 v[202:203], v10 offset:51712
    s_add_u32 m0, m0, 4096
    v_mfma_f32_32x32x16_bf16 v[176:191], a[88:91], v[212:215], v[176:191]
    ds_read_b64_tr_b16 v[204:205], v11 offset:51200
    ds_read_b64_tr_b16 v[206:207], v11 offset:51712
    s_add_u32 s86, s86, 32768
    s_waitcnt lgkmcnt(8)
    v_mfma_f32_32x32x16_bf16 v[160:175], a[92:95], v[216:219], v[160:175]
    ds_read_b64_tr_b16 v[208:209], v10 offset:53248
    ds_read_b64_tr_b16 v[210:211], v10 offset:53760
    buffer_load_dwordx4 v228, s[24:27], s86 offen offset:0 lds
    v_mfma_f32_32x32x16_bf16 v[176:191], a[92:95], v[220:223], v[176:191]
    ds_read_b64_tr_b16 v[212:213], v11 offset:53248
    ds_read_b64_tr_b16 v[214:215], v11 offset:53760
    buffer_load_dwordx4 v229, s[24:27], s86 offen offset:1024 lds
    s_waitcnt lgkmcnt(8)
    v_mfma_f32_32x32x16_bf16 v[160:175], a[96:99], v[192:195], v[160:175]
    ds_read_b64_tr_b16 v[216:217], v10 offset:55296
    ds_read_b64_tr_b16 v[218:219], v10 offset:55808
    buffer_load_dwordx4 v230, s[24:27], s86 offen offset:2048 lds
    v_mfma_f32_32x32x16_bf16 v[176:191], a[96:99], v[196:199], v[176:191]
    ds_read_b64_tr_b16 v[220:221], v11 offset:55296
    ds_read_b64_tr_b16 v[222:223], v11 offset:55808
    buffer_load_dwordx4 v231, s[24:27], s86 offen offset:3072 lds
    s_waitcnt lgkmcnt(8)
    v_mfma_f32_32x32x16_bf16 v[160:175], a[100:103], v[200:203], v[160:175]
    ds_read_b64_tr_b16 v[192:193], v10 offset:57344
    ds_read_b64_tr_b16 v[194:195], v10 offset:57856
    v_mfma_f32_32x32x16_bf16 v[176:191], a[100:103], v[204:207], v[176:191]
    ds_read_b64_tr_b16 v[196:197], v11 offset:57344
    ds_read_b64_tr_b16 v[198:199], v11 offset:57856
    s_waitcnt lgkmcnt(8)
    v_mfma_f32_32x32x16_bf16 v[160:175], a[104:107], v[208:211], v[160:175]
    ds_read_b64_tr_b16 v[200:201], v10 offset:59392
    ds_read_b64_tr_b16 v[202:203], v10 offset:59904
    v_mfma_f32_32x32x16_bf16 v[176:191], a[104:107], v[212:215], v[176:191]
    ds_read_b64_tr_b16 v[204:205], v11 offset:59392
    ds_read_b64_tr_b16 v[206:207], v11 offset:59904
    s_waitcnt lgkmcnt(8)
    v_mfma_f32_32x32x16_bf16 v[160:175], a[108:111], v[216:219], v[160:175]
    ds_read_b64_tr_b16 v[208:209], v10 offset:61440
    ds_read_b64_tr_b16 v[210:211], v10 offset:61952
    v_mfma_f32_32x32x16_bf16 v[176:191], a[108:111], v[220:223], v[176:191]
    ds_read_b64_tr_b16 v[212:213], v11 offset:61440
    ds_read_b64_tr_b16 v[214:215], v11 offset:61952
    s_waitcnt lgkmcnt(8)
    v_mfma_f32_32x32x16_bf16 v[160:175], a[112:115], v[192:195], v[160:175]
    ds_read_b64_tr_b16 v[216:217], v10 offset:63488
    ds_read_b64_tr_b16 v[218:219], v10 offset:64000
    v_mfma_f32_32x32x16_bf16 v[176:191], a[112:115], v[196:199], v[176:191]
    ds_read_b64_tr_b16 v[220:221], v11 offset:63488
    ds_read_b64_tr_b16 v[222:223], v11 offset:64000
    s_waitcnt lgkmcnt(8)
    v_mfma_f32_32x32x16_bf16 v[160:175], a[116:119], v[200:203], v[160:175]
    v_mfma_f32_32x32x16_bf16 v[176:191], a[116:119], v[204:207], v[176:191]
    s_waitcnt lgkmcnt(4)
    v_mfma_f32_32x32x16_bf16 v[160:175], a[120:123], v[208:211], v[160:175]
    v_mfma_f32_32x32x16_bf16 v[176:191], a[120:123], v[212:215], v[176:191]
    s_waitcnt lgkmcnt(0)
    v_mfma_f32_32x32x16_bf16 v[160:175], a[124:127], v[216:219], v[160:175]
    v_mfma_f32_32x32x16_bf16 v[176:191], a[124:127], v[220:223], v[176:191]
    ds_read_b64_tr_b16 v[236:237], v44 offset:0
    ds_read_b64_tr_b16 v[238:239], v45 offset:1024
    ds_read_b64_tr_b16 v[240:241], v42 offset:0
    ds_read_b64_tr_b16 v[242:243], v43 offset:1024
    s_mov_b32 s97, 0x80000
L_rc12:
    s_waitcnt vmcnt(8)
    v_and_b32 v20, v109, v111
    v_cmp_ne_u32 vcc, 1, v20
    s_cbranch_vccz L_rcx12
    s_sleep 1
    buffer_load_dwordx4 v[108:111], v18, s[36:39], s61 offen offset:1024 sc1
    s_sub_u32 s97, s97, 1
    s_waitcnt vmcnt(0)
    s_cbranch_scc0 L_rc12
L_rcx12:
    v_mov_b32 v100, v108
    v_mov_b32 v102, v108
    v_mov_b32 v101, v110
    v_mov_b32 v103, v110
    v_permlane32_swap_b32 v100, v102
    s_nop 0
    v_permlane32_swap_b32 v101, v103
    v_pk_fma_f32 v[48:49], v[64:65], v[100:101], v[80:81] op_sel:[0,1,0] op_sel_hi:[1,1,1]
    v_pk_fma_f32 v[50:51], v[66:67], v[100:101], v[82:83] op_sel:[0,1,0] op_sel_hi:[1,1,1]
    v_pk_fma_f32 v[160:161], v[160:161], v[100:101], v[48:49] op_sel:[0,0,0] op_sel_hi:[1,0,1]
    v_pk_fma_f32 v[162:163], v[162:163], v[100:101], v[50:51] op_sel:[0,0,0] op_sel_hi:[1,0,1]
    v_exp_f32 v48, v160
    v_exp_f32 v49, v161
    v_exp_f32 v50, v162
    v_exp_f32 v51, v163
    v_pk_add_f32 v[48:49], v[48:49], 1.0 op_sel_hi:[1,0]
    v_pk_add_f32 v[50:51], v[50:51], 1.0 op_sel_hi:[1,0]
    v_rcp_f32 v48, v48
    v_rcp_f32 v49, v49
    v_rcp_f32 v50, v50
    v_rcp_f32 v51, v51
    v_pk_mul_f32 v[48:49], v[48:49], v[160:161]
    v_pk_mul_f32 v[50:51], v[50:51], v[162:163]
    v_cvt_pk_bf16_f32 v24, v48, v49
    v_cvt_pk_bf16_f32 v25, v50, v51
    v_pk_fma_f32 v[48:49], v[68:69], v[100:101], v[84:85] op_sel:[0,1,0] op_sel_hi:[1,1,1]
    v_pk_fma_f32 v[50:51], v[70:71], v[100:101], v[86:87] op_sel:[0,1,0] op_sel_hi:[1,1,1]
    v_pk_fma_f32 v[164:165], v[164:165], v[100:101], v[48:49] op_sel:[0,0,0] op_sel_hi:[1,0,1]
    v_pk_fma_f32 v[166:167], v[166:167], v[100:101], v[50:51] op_sel:[0,0,0] op_sel_hi:[1,0,1]
    v_exp_f32 v48, v164
    v_exp_f32 v49, v165
    v_exp_f32 v50, v166
    v_exp_f32 v51, v167
    v_pk_add_f32 v[48:49], v[48:49], 1.0 op_sel_hi:[1,0]
    v_pk_add_f32 v[50:51], v[50:51], 1.0 op_sel_hi:[1,0]
    v_rcp_f32 v48, v48
    v_rcp_f32 v49, v49
    v_rcp_f32 v50, v50
    v_rcp_f32 v51, v51
    v_pk_mul_f32 v[48:49], v[48:49], v[164:165]
    v_pk_mul_f32 v[50:51], v[50:51], v[166:167]
    v_cvt_pk_bf16_f32 v26, v48, v49
    v_cvt_pk_bf16_f32 v27, v50, v51
    v_pk_fma_f32 v[48:49], v[72:73], v[100:101], v[88:89] op_sel:[0,1,0] op_sel_hi:[1,1,1]
    v_pk_fma_f32 v[50:51], v[74:75], v[100:101], v[90:91] op_sel:[0,1,0] op_sel_hi:[1,1,1]
    v_pk_fma_f32 v[168:169], v[168:169], v[100:101], v[48:49] op_sel:[0,0,0] op_sel_hi:[1,0,1]
    v_pk_fma_f32 v[170:171], v[170:171], v[100:101], v[50:51] op_sel:[0,0,0] op_sel_hi:[1,0,1]
    v_exp_f32 v48, v168
    v_exp_f32 v49, v169
    v_exp_f32 v50, v170
    v_exp_f32 v51, v171
    v_pk_add_f32 v[48:49], v[48:49], 1.0 op_sel_hi:[1,0]
    v_pk_add_f32 v[50:51], v[50:51], 1.0 op_sel_hi:[1,0]
    v_rcp_f32 v48, v48
    v_rcp_f32 v49, v49
    v_rcp_f32 v50, v50
    v_rcp_f32 v51, v51
    v_pk_mul_f32 v[48:49], v[48:49], v[168:169]
    v_pk_mul_f32 v[50:51], v[50:51], v[170:171]
    v_cvt_pk_bf16_f32 v28, v48, v49
    v_cvt_pk_bf16_f32 v29, v50, v51
    v_pk_fma_f32 v[48:49], v[76:77], v[100:101], v[92:93] op_sel:[0,1,0] op_sel_hi:[1,1,1]
    v_pk_fma_f32 v[50:51], v[78:79], v[100:101], v[94:95] op_sel:[0,1,0] op_sel_hi:[1,1,1]
    v_pk_fma_f32 v[172:173], v[172:173], v[100:101], v[48:49] op_sel:[0,0,0] op_sel_hi:[1,0,1]
    v_pk_fma_f32 v[174:175], v[174:175], v[100:101], v[50:51] op_sel:[0,0,0] op_sel_hi:[1,0,1]
    v_exp_f32 v48, v172
    v_exp_f32 v49, v173
    v_exp_f32 v50, v174
    v_exp_f32 v51, v175
    v_pk_add_f32 v[48:49], v[48:49], 1.0 op_sel_hi:[1,0]
    v_pk_add_f32 v[50:51], v[50:51], 1.0 op_sel_hi:[1,0]
    v_rcp_f32 v48, v48
    v_rcp_f32 v49, v49
    v_rcp_f32 v50, v50
    v_rcp_f32 v51, v51
    v_pk_mul_f32 v[48:49], v[48:49], v[172:173]
    v_pk_mul_f32 v[50:51], v[50:51], v[174:175]
    v_cvt_pk_bf16_f32 v30, v48, v49
    v_cvt_pk_bf16_f32 v31, v50, v51
    s_add_u32 s58, s57, 229376
    buffer_store_dwordx4 v[24:27], v18, s[36:39], s58 offen offset:0 sc1
    buffer_store_dwordx4 v[28:31], v18, s[36:39], s58 offen offset:1024 sc1
    v_pk_fma_f32 v[48:49], v[64:65], v[102:103], v[80:81] op_sel:[0,1,0] op_sel_hi:[1,1,1]
    v_pk_fma_f32 v[50:51], v[66:67], v[102:103], v[82:83] op_sel:[0,1,0] op_sel_hi:[1,1,1]
    v_pk_fma_f32 v[176:177], v[176:177], v[102:103], v[48:49] op_sel:[0,0,0] op_sel_hi:[1,0,1]
    v_pk_fma_f32 v[178:179], v[178:179], v[102:103], v[50:51] op_sel:[0,0,0] op_sel_hi:[1,0,1]
    v_exp_f32 v48, v176
    v_exp_f32 v49, v177
    v_exp_f32 v50, v178
    v_exp_f32 v51, v179
    v_pk_add_f32 v[48:49], v[48:49], 1.0 op_sel_hi:[1,0]
    v_pk_add_f32 v[50:51], v[50:51], 1.0 op_sel_hi:[1,0]
    v_rcp_f32 v48, v48
    v_rcp_f32 v49, v49
    v_rcp_f32 v50, v50
    v_rcp_f32 v51, v51
    v_pk_mul_f32 v[48:49], v[48:49], v[176:177]
    v_pk_mul_f32 v[50:51], v[50:51], v[178:179]
    v_cvt_pk_bf16_f32 v32, v48, v49
    v_cvt_pk_bf16_f32 v33, v50, v51
    v_pk_fma_f32 v[48:49], v[68:69], v[102:103], v[84:85] op_sel:[0,1,0] op_sel_hi:[1,1,1]
    v_pk_fma_f32 v[50:51], v[70:71], v[102:103], v[86:87] op_sel:[0,1,0] op_sel_hi:[1,1,1]
    v_pk_fma_f32 v[180:181], v[180:181], v[102:103], v[48:49] op_sel:[0,0,0] op_sel_hi:[1,0,1]
    v_pk_fma_f32 v[182:183], v[182:183], v[102:103], v[50:51] op_sel:[0,0,0] op_sel_hi:[1,0,1]
    v_exp_f32 v48, v180
    v_exp_f32 v49, v181
    v_exp_f32 v50, v182
    v_exp_f32 v51, v183
    v_pk_add_f32 v[48:49], v[48:49], 1.0 op_sel_hi:[1,0]
    v_pk_add_f32 v[50:51], v[50:51], 1.0 op_sel_hi:[1,0]
    v_rcp_f32 v48, v48
    v_rcp_f32 v49, v49
    v_rcp_f32 v50, v50
    v_rcp_f32 v51, v51
    v_pk_mul_f32 v[48:49], v[48:49], v[180:181]
    v_pk_mul_f32 v[50:51], v[50:51], v[182:183]
    v_cvt_pk_bf16_f32 v34, v48, v49
    v_cvt_pk_bf16_f32 v35, v50, v51
    v_pk_fma_f32 v[48:49], v[72:73], v[102:103], v[88:89] op_sel:[0,1,0] op_sel_hi:[1,1,1]
    v_pk_fma_f32 v[50:51], v[74:75], v[102:103], v[90:91] op_sel:[0,1,0] op_sel_hi:[1,1,1]
    v_pk_fma_f32 v[184:185], v[184:185], v[102:103], v[48:49] op_sel:[0,0,0] op_sel_hi:[1,0,1]
    v_pk_fma_f32 v[186:187], v[186:187], v[102:103], v[50:51] op_sel:[0,0,0] op_sel_hi:[1,0,1]
    v_exp_f32 v48, v184
    v_exp_f32 v49, v185
    v_exp_f32 v50, v186
    v_exp_f32 v51, v187
    v_pk_add_f32 v[48:49], v[48:49], 1.0 op_sel_hi:[1,0]
    v_pk_add_f32 v[50:51], v[50:51], 1.0 op_sel_hi:[1,0]
    v_rcp_f32 v48, v48
    v_rcp_f32 v49, v49
    v_rcp_f32 v50, v50
    v_rcp_f32 v51, v51
    v_pk_mul_f32 v[48:49], v[48:49], v[184:185]
    v_pk_mul_f32 v[50:51], v[50:51], v[186:187]
    v_cvt_pk_bf16_f32 v36, v48, v49
    v_cvt_pk_bf16_f32 v37, v50, v51
    v_pk_fma_f32 v[48:49], v[76:77], v[102:103], v[92:93] op_sel:[0,1,0] op_sel_hi:[1,1,1]
    v_pk_fma_f32 v[50:51], v[78:79], v[102:103], v[94:95] op_sel:[0,1,0] op_sel_hi:[1,1,1]
    v_pk_fma_f32 v[188:189], v[188:189], v[102:103], v[48:49] op_sel:[0,0,0] op_sel_hi:[1,0,1]
    v_pk_fma_f32 v[190:191], v[190:191], v[102:103], v[50:51] op_sel:[0,0,0] op_sel_hi:[1,0,1]
    v_exp_f32 v48, v188
    v_exp_f32 v49, v189
    v_exp_f32 v50, v190
    v_exp_f32 v51, v191
    v_pk_add_f32 v[48:49], v[48:49], 1.0 op_sel_hi:[1,0]
    v_pk_add_f32 v[50:51], v[50:51], 1.0 op_sel_hi:[1,0]
    v_rcp_f32 v48, v48
    v_rcp_f32 v49, v49
    v_rcp_f32 v50, v50
    v_rcp_f32 v51, v51
    v_pk_mul_f32 v[48:49], v[48:49], v[188:189]
    v_pk_mul_f32 v[50:51], v[50:51], v[190:191]
    v_cvt_pk_bf16_f32 v38, v48, v49
    v_cvt_pk_bf16_f32 v39, v50, v51
    buffer_load_dword v12, v14, s[36:39], s62 offen sc1
    s_add_u32 s58, s57, 344064
    buffer_store_dwordx4 v[32:35], v18, s[36:39], s58 offen offset:0 sc1
    buffer_store_dwordx4 v[36:39], v18, s[36:39], s58 offen offset:1024 sc1
    s_branch L_g1done
L_stat:
    s_add_u32 m0, s56, 0
    s_and_b32 s59, s59, 0x1fffff
    buffer_load_dwordx4 v56, s[8:11], s59 offen sc1 lds
    buffer_load_dwordx4 v57, s[8:11], s59 offen offset:1024 sc1 lds
    s_add_u32 s59, s59, 262144
    s_add_u32 m0, s56, 8192
    s_and_b32 s59, s59, 0x1fffff
    buffer_load_dwordx4 v56, s[8:11], s59 offen sc1 lds
    buffer_load_dwordx4 v57, s[8:11], s59 offen offset:1024 sc1 lds
    s_add_u32 s59, s59, 262144
    s_add_u32 m0, s56, 16384
    s_and_b32 s59, s59, 0x1fffff
    buffer_load_dwordx4 v56, s[8:11], s59 offen sc1 lds
    buffer_load_dwordx4 v57, s[8:11], s59 offen offset:1024 sc1 lds
    s_add_u32 s59, s59, 262144
    s_add_u32 m0, s56, 24576
    s_and_b32 s59, s59, 0x1fffff
    buffer_load_dwordx4 v56, s[8:11], s59 offen sc1 lds
    buffer_load_dwordx4 v57, s[8:11], s59 offen offset:1024 sc1 lds
    s_add_u32 s59, s59, 262144
    s_add_u32 m0, s56, 32768
    s_and_b32 s59, s59, 0x1fffff
    buffer_load_dwordx4 v56, s[8:11], s59 offen sc1 lds
    buffer_load_dwordx4 v57, s[8:11], s59 offen offset:1024 sc1 lds
    s_add_u32 s59, s59, 262144
    s_add_u32 m0, s56, 40960
    s_and_b32 s59, s59, 0x1fffff
    buffer_load_dwordx4 v56, s[8:11], s59 offen sc1 lds
    buffer_load_dwordx4 v57, s[8:11], s59 offen offset:1024 sc1 lds
    s_add_u32 s59, s59, 262144
    s_add_u32 m0, s56, 49152
    s_and_b32 s59, s59, 0x1fffff
    buffer_load_dwordx4 v56, s[8:11], s59 offen sc1 lds
    buffer_load_dwordx4 v57, s[8:11], s59 offen offset:1024 sc1 lds
    s_add_u32 s59, s59, 262144
    s_add_u32 m0, s56, 57344
    s_and_b32 s59, s59, 0x1fffff
    buffer_load_dwordx4 v56, s[8:11], s59 offen sc1 lds
    buffer_load_dwordx4 v57, s[8:11], s59 offen offset:1024 sc1 lds
    s_add_u32 s59, s59, 262144
    v_lshrrev_b32 v5, 4, v2
    v_bfe_u32 v6, v2, 2, 2
    v_lshl_add_u32 v12, v5, 3, v6
    v_lshlrev_b32 v12, 7, v12
    v_and_b32 v6, 2, v6
    v_and_b32 v5, 1, v5
    v_or_b32 v6, v6, v5
    v_lshl_add_u32 v12, v6, 5, v12
    v_and_b32 v5, 3, v2
    v_lshl_add_u32 v12, v5, 3, v12
    s_lshl_b32 s68, s3, 5
    v_xor_b32 v12, s68, v12
    v_mov_b32 v36, s101
    v_mov_b32 v37, s101
    v_mov_b32 v38, s101
    v_mov_b32 v39, s101
    s_waitcnt vmcnt(12)
    s_barrier
    ds_read_b64_tr_b16 v[192:193], v12 offset:0
    ds_read_b64_tr_b16 v[194:195], v12 offset:512
    ds_read_b64_tr_b16 v[196:197], v12 offset:4096
    ds_read_b64_tr_b16 v[198:199], v12 offset:4608
    ds_read_b64_tr_b16 v[200:201], v12 offset:8192
    ds_read_b64_tr_b16 v[202:203], v12 offset:8704
    ds_read_b64_tr_b16 v[204:205], v12 offset:12288
    ds_read_b64_tr_b16 v[206:207], v12 offset:12800
    s_waitcnt lgkmcnt(6)
    v_mfma_f32_16x16x32_bf16 v[128:131], v[192:195], v[192:195], 0
    v_mfma_f32_16x16x32_bf16 v[132:135], v[36:39], v[192:195], 0
    s_waitcnt lgkmcnt(4)
    v_mfma_f32_16x16x32_bf16 v[128:131], v[196:199], v[196:199], v[128:131]
    v_mfma_f32_16x16x32_bf16 v[132:135], v[36:39], v[196:199], v[132:135]
    s_waitcnt lgkmcnt(2)
    v_mfma_f32_16x16x32_bf16 v[128:131], v[200:203], v[200:203], v[128:131]
    v_mfma_f32_16x16x32_bf16 v[132:135], v[36:39], v[200:203], v[132:135]
    s_waitcnt lgkmcnt(0)
    v_mfma_f32_16x16x32_bf16 v[128:131], v[204:207], v[204:207], v[128:131]
    v_mfma_f32_16x16x32_bf16 v[132:135], v[36:39], v[204:207], v[132:135]
    s_waitcnt vmcnt(8)
    s_barrier
    ds_read_b64_tr_b16 v[192:193], v12 offset:16384
    ds_read_b64_tr_b16 v[194:195], v12 offset:16896
    ds_read_b64_tr_b16 v[196:197], v12 offset:20480
    ds_read_b64_tr_b16 v[198:199], v12 offset:20992
    ds_read_b64_tr_b16 v[200:201], v12 offset:24576
    ds_read_b64_tr_b16 v[202:203], v12 offset:25088
    ds_read_b64_tr_b16 v[204:205], v12 offset:28672
    ds_read_b64_tr_b16 v[206:207], v12 offset:29184
    s_waitcnt lgkmcnt(6)
    v_mfma_f32_16x16x32_bf16 v[128:131], v[192:195], v[192:195], v[128:131]
    v_mfma_f32_16x16x32_bf16 v[132:135], v[36:39], v[192:195], v[132:135]
    s_waitcnt lgkmcnt(4)
    v_mfma_f32_16x16x32_bf16 v[128:131], v[196:199], v[196:199], v[128:131]
    v_mfma_f32_16x16x32_bf16 v[132:135], v[36:39], v[196:199], v[132:135]
    s_waitcnt lgkmcnt(2)
    v_mfma_f32_16x16x32_bf16 v[128:131], v[200:203], v[200:203], v[128:131]
    v_mfma_f32_16x16x32_bf16 v[132:135], v[36:39], v[200:203], v[132:135]
    s_waitcnt lgkmcnt(0)
    v_mfma_f32_16x16x32_bf16 v[128:131], v[204:207], v[204:207], v[128:131]
    v_mfma_f32_16x16x32_bf16 v[132:135], v[36:39], v[204:207], v[132:135]
    s_waitcnt vmcnt(4)
    s_barrier
    ds_read_b64_tr_b16 v[192:193], v12 offset:32768
    ds_read_b64_tr_b16 v[194:195], v12 offset:33280
    ds_read_b64_tr_b16 v[196:197], v12 offset:36864
    ds_read_b64_tr_b16 v[198:199], v12 offset:37376
    ds_read_b64_tr_b16 v[200:201], v12 offset:40960
    ds_read_b64_tr_b16 v[202:203], v12 offset:41472
    ds_read_b64_tr_b16 v[204:205], v12 offset:45056
    ds_read_b64_tr_b16 v[206:207], v12 offset:45568
    s_waitcnt lgkmcnt(6)
    v_mfma_f32_16x16x32_bf16 v[128:131], v[192:195], v[192:195], v[128:131]
    v_mfma_f32_16x16x32_bf16 v[132:135], v[36:39], v[192:195], v[132:135]
    s_waitcnt lgkmcnt(4)
    v_mfma_f32_16x16x32_bf16 v[128:131], v[196:199], v[196:199], v[128:131]
    v_mfma_f32_16x16x32_bf16 v[132:135], v[36:39], v[196:199], v[132:135]
    s_waitcnt lgkmcnt(2)
    v_mfma_f32_16x16x32_bf16 v[128:131], v[200:203], v[200:203], v[128:131]
    v_mfma_f32_16x16x32_bf16 v[132:135], v[36:39], v[200:203], v[132:135]
    s_waitcnt lgkmcnt(0)
    v_mfma_f32_16x16x32_bf16 v[128:131], v[204:207], v[204:207], v[128:131]
    v_mfma_f32_16x16x32_bf16 v[132:135], v[36:39], v[204:207], v[132:135]
    s_waitcnt vmcnt(0)
    s_barrier
    ds_read_b64_tr_b16 v[192:193], v12 offset:49152
    ds_read_b64_tr_b16 v[194:195], v12 offset:49664
    ds_read_b64_tr_b16 v[196:197], v12 offset:53248
    ds_read_b64_tr_b16 v[198:199], v12 offset:53760
    ds_read_b64_tr_b16 v[200:201], v12 offset:57344
    ds_read_b64_tr_b16 v[202:203], v12 offset:57856
    ds_read_b64_tr_b16 v[204:205], v12 offset:61440
    ds_read_b64_tr_b16 v[206:207], v12 offset:61952
    s_waitcnt lgkmcnt(6)
    v_mfma_f32_16x16x32_bf16 v[128:131], v[192:195], v[192:195], v[128:131]
    v_mfma_f32_16x16x32_bf16 v[132:135], v[36:39], v[192:195], v[132:135]
    s_waitcnt lgkmcnt(4)
    v_mfma_f32_16x16x32_bf16 v[128:131], v[196:199], v[196:199], v[128:131]
    v_mfma_f32_16x16x32_bf16 v[132:135], v[36:39], v[196:199], v[132:135]
    s_waitcnt lgkmcnt(2)
    v_mfma_f32_16x16x32_bf16 v[128:131], v[200:203], v[200:203], v[128:131]
    v_mfma_f32_16x16x32_bf16 v[132:135], v[36:39], v[200:203], v[132:135]
    s_waitcnt lgkmcnt(0)
    v_mfma_f32_16x16x32_bf16 v[128:131], v[204:207], v[204:207], v[128:131]
    v_mfma_f32_16x16x32_bf16 v[132:135], v[36:39], v[204:207], v[132:135]
    s_mov_b32 vcc_lo, 0x22222222
    s_mov_b32 vcc_hi, 0x22222222
    s_nop 4
    v_cndmask_b32 v128, v128, v129, vcc
    s_mov_b32 vcc_lo, 0x44444444
    s_mov_b32 vcc_hi, 0x44444444
    v_cndmask_b32 v128, v128, v130, vcc
    s_mov_b32 vcc_lo, 0x88888888
    s_mov_b32 vcc_hi, 0x88888888
    v_cndmask_b32 v128, v128, v131, vcc
    v_mul_f32 v132, 0x3b000000, v132
    v_mul_f32 v128, 0x3b000000, v128
    v_fma_f32 v128, -v132, v132, v128
    v_max_f32 v128, 0, v128
    v_cvt_pk_bf16_f32 v129, v132, v128
    v_lshlrev_b32 v132, 16, v129
    v_and_b32 v128, 0xffff0000, v129
    v_add_f32 v128, 0x3727c5ac, v128
    v_cvt_pk_bf16_f32 v128, v128, v128
    v_lshlrev_b32 v128, 16, v128
    v_sqrt_f32 v128, v128
    s_nop 0
    v_cvt_pk_bf16_f32 v128, v128, v128
    v_lshlrev_b32 v128, 16, v128
    v_rcp_f32 v136, v128
    s_nop 0
    v_mul_f32 v136, 0xbfb8aa3b, v136
    v_mul_f32 v138, -v132, v136
    v_mov_b32 v137, 1
    v_mov_b32 v139, 1
    v_and_b32 v5, 15, v2
    v_lshlrev_b32 v5, 4, v5
    s_and_b32 s67, s88, 1
    s_lshl_b32 s67, s67, 10
    s_lshl_b32 s68, s3, 8
    s_add_u32 s67, s67, s68
    s_add_u32 s67, s67, s61
    s_mov_b32 exec_lo, 0x00f0000f
    s_mov_b32 exec_hi, 0xf0000f00
    buffer_store_dwordx4 v[136:139], v5, s[36:39], s67 offen sc1
    s_mov_b64 exec, -1
    s_lshl_b32 s66, s93, 18
    s_lshl_b32 s67, s3, 16
    s_add_u32 s66, s66, s67
    s_lshl_b32 s67, s0, 6
    s_add_u32 s66, s66, s67
    s_add_u32 m0, s56, 131072
    s_add_u32 s66, s66, 4194304
    buffer_load_dwordx4 v58, s[36:39], s66 offen sc1 lds
    buffer_load_dwordx4 v59, s[36:39], s66 offen offset:1024 sc1 lds
    s_cmp_eq_u32 s3, 3
    s_cbranch_scc0 L_w3_13
    ds_read_b64_tr_b16 a[128:129], v232 offset:0
    ds_read_b64_tr_b16 a[130:131], v233 offset:1024
    ds_read_b64_tr_b16 a[132:133], v234 offset:0
    ds_read_b64_tr_b16 a[134:135], v235 offset:1024
    ds_read_b64_tr_b16 a[136:137], v232 offset:2048
    ds_read_b64_tr_b16 a[138:139], v233 offset:3072
    ds_read_b64_tr_b16 a[140:141], v234 offset:2048
    ds_read_b64_tr_b16 a[142:143], v235 offset:3072
    ds_read_b64_tr_b16 a[144:145], v232 offset:4096
    ds_read_b64_tr_b16 a[146:147], v233 offset:5120
    ds_read_b64_tr_b16 a[148:149], v234 offset:4096
    ds_read_b64_tr_b16 a[150:151], v235 offset:5120
    ds_read_b64_tr_b16 a[152:153], v232 offset:6144
    ds_read_b64_tr_b16 a[154:155], v233 offset:7168
    ds_read_b64_tr_b16 a[156:157], v234 offset:6144
    ds_read_b64_tr_b16 a[158:159], v235 offset:7168
    ds_read_b64_tr_b16 a[160:161], v232 offset:8192
    ds_read_b64_tr_b16 a[162:163], v233 offset:9216
    ds_read_b64_tr_b16 a[164:165], v234 offset:8192
    ds_read_b64_tr_b16 a[166:167], v235 offset:9216
    ds_read_b64_tr_b16 a[168:169], v232 offset:10240
    ds_read_b64_tr_b16 a[170:171], v233 offset:11264
    ds_read_b64_tr_b16 a[172:173], v234 offset:10240
    ds_read_b64_tr_b16 a[174:175], v235 offset:11264
    ds_read_b64_tr_b16 a[176:177], v232 offset:12288
    ds_read_b64_tr_b16 a[178:179], v233 offset:13312
    ds_read_b64_tr_b16 a[180:181], v234 offset:12288
    ds_read_b64_tr_b16 a[182:183], v235 offset:13312
    ds_read_b64_tr_b16 a[184:185], v232 offset:14336
    ds_read_b64_tr_b16 a[186:187], v233 offset:15360
    ds_read_b64_tr_b16 a[188:189], v234 offset:14336
    ds_read_b64_tr_b16 a[190:191], v235 offset:15360
    ds_read_b64_tr_b16 a[192:193], v232 offset:16384
    ds_read_b64_tr_b16 a[194:195], v233 offset:17408
    ds_read_b64_tr_b16 a[196:197], v234 offset:16384
    ds_read_b64_tr_b16 a[198:199], v235 offset:17408
    ds_read_b64_tr_b16 a[200:201], v232 offset:18432
    ds_read_b64_tr_b16 a[202:203], v233 offset:19456
    ds_read_b64_tr_b16 a[204:205], v234 offset:18432
    ds_read_b64_tr_b16 a[206:207], v235 offset:19456
    ds_read_b64_tr_b16 a[208:209], v232 offset:20480
    ds_read_b64_tr_b16 a[210:211], v233 offset:21504
    ds_read_b64_tr_b16 a[212:213], v234 offset:20480
    ds_read_b64_tr_b16 a[214:215], v235 offset:21504
    ds_read_b64_tr_b16 a[216:217], v232 offset:22528
    ds_read_b64_tr_b16 a[218:219], v233 offset:23552
    ds_read_b64_tr_b16 a[220:221], v234 offset:22528
    ds_read_b64_tr_b16 a[222:223], v235 offset:23552
    ds_read_b64_tr_b16 a[224:225], v232 offset:24576
    ds_read_b64_tr_b16 a[226:227], v233 offset:25600
    ds_read_b64_tr_b16 a[228:229], v234 offset:24576
    ds_read_b64_tr_b16 a[230:231], v235 offset:25600
    ds_read_b64_tr_b16 a[232:233], v232 offset:26624
    ds_read_b64_tr_b16 a[234:235], v233 offset:27648
    ds_read_b64_tr_b16 a[236:237], v234 offset:26624
    ds_read_b64_tr_b16 a[238:239], v235 offset:27648
    ds_read_b64_tr_b16 a[240:241], v232 offset:28672
    ds_read_b64_tr_b16 a[242:243], v233 offset:29696
    ds_read_b64_tr_b16 a[244:245], v234 offset:28672
    ds_read_b64_tr_b16 a[246:247], v235 offset:29696
    ds_read_b64_tr_b16 a[248:249], v232 offset:30720
    ds_read_b64_tr_b16 a[250:251], v233 offset:31744
    ds_read_b64_tr_b16 a[252:253], v234 offset:30720
    ds_read_b64_tr_b16 a[254:255], v235 offset:31744
    s_waitcnt lgkmcnt(0)
L_w3_13:
    s_waitcnt vmcnt(0)
    s_barrier
    v_add_u32 v232, s89, v246
    v_add_u32 v233, s89, v247
    v_add_u32 v234, s89, v248
    v_add_u32 v235, s89, v249
    s_add_u32 s98, s91, 4
    s_add_u32 m0, s89, 0
    s_cmp_ge_u32 s98, 7
    s_cselect_b32 s86, 7, 0
    s_sub_u32 s98, s98, s86
    s_lshl_b32 s86, s98, 16
    s_add_u32 s86, s86, s90
    buffer_load_dwordx4 v228, s[24:27], s86 offen offset:0 lds
    buffer_load_dwordx4 v229, s[24:27], s86 offen offset:1024 lds
    buffer_load_dwordx4 v230, s[24:27], s86 offen offset:2048 lds
    buffer_load_dwordx4 v231, s[24:27], s86 offen offset:3072 lds
    s_add_u32 m0, m0, 4096
    s_add_u32 s86, s86, 32768
    buffer_load_dwordx4 v228, s[24:27], s86 offen offset:0 lds
    buffer_load_dwordx4 v229, s[24:27], s86 offen offset:1024 lds
    buffer_load_dwordx4 v230, s[24:27], s86 offen offset:2048 lds
    buffer_load_dwordx4 v231, s[24:27], s86 offen offset:3072 lds
    s_add_u32 s98, s91, 5
    s_add_u32 m0, s89, 8192
    s_cmp_ge_u32 s98, 7
    s_cselect_b32 s86, 7, 0
    s_sub_u32 s98, s98, s86
    s_lshl_b32 s86, s98, 16
    s_add_u32 s86, s86, s90
    buffer_load_dwordx4 v228, s[24:27], s86 offen offset:0 lds
    buffer_load_dwordx4 v229, s[24:27], s86 offen offset:1024 lds
    buffer_load_dwordx4 v230, s[24:27], s86 offen offset:2048 lds
    buffer_load_dwordx4 v231, s[24:27], s86 offen offset:3072 lds
    s_add_u32 m0, m0, 4096
    s_add_u32 s86, s86, 32768
    buffer_load_dwordx4 v228, s[24:27], s86 offen offset:0 lds
    buffer_load_dwordx4 v229, s[24:27], s86 offen offset:1024 lds
    buffer_load_dwordx4 v230, s[24:27], s86 offen offset:2048 lds
    buffer_load_dwordx4 v231, s[24:27], s86 offen offset:3072 lds
    ds_read_b64_tr_b16 v[236:237], v44 offset:0
    ds_read_b64_tr_b16 v[238:239], v45 offset:1024
    ds_read_b64_tr_b16 v[240:241], v42 offset:0
    ds_read_b64_tr_b16 v[242:243], v43 offset:1024
    v_mov_b32 v12, 0
    s_mov_b32 s97, 0x80000
L_rc14:
    v_cmp_ne_u32 vcc, 1, v12
    s_cbranch_vccz L_rcx14
    s_sleep 1
    s_sleep 8
    buffer_load_dword v12, v14, s[36:39], s62 offen sc1
    s_sub_u32 s97, s97, 1
    s_waitcnt vmcnt(0)
    s_cbranch_scc0 L_rc14
L_rcx14:
    buffer_load_dword v12, v14, s[36:39], s62 offen sc1
    s_waitcnt vmcnt(0)
L_g1done:
    v_add_u32 v232, s89, v246
    v_add_u32 v233, s89, v247
    v_add_u32 v234, s89, v248
    v_add_u32 v235, s89, v249
    v_lshrrev_b32 v5, 5, v2
    v_lshlrev_b32 v5, 4, v5
    s_lshl_b32 s55, s3, 6
    s_add_u32 s55, s55, 152960
    v_add_u32 v5, s55, v5
    s_mov_b32 s54, s0
    s_mul_i32 s56, s54, 114688
    v_lshlrev_b32 v6, 4, v2
    v_add_u32 v3, s56, v6
    v_add_u32 v4, 229376, v3
    s_mul_i32 s58, s3, 28672
    s_add_u32 s58, s58, 8388608
    s_add_u32 s59, s58, 28672
    s_lshl_b32 s56, s91, 12
    s_add_u32 s56, s56, s58
    s_waitcnt vmcnt(5)
    ds_read_b64_tr_b16 a[0:1], v232 offset:0
    ds_read_b64_tr_b16 a[2:3], v233 offset:1024
    ds_read_b64_tr_b16 a[4:5], v234 offset:0
    ds_read_b64_tr_b16 a[6:7], v235 offset:1024
    ds_read_b64_tr_b16 a[8:9], v232 offset:2048
    ds_read_b64_tr_b16 a[10:11], v233 offset:3072
    ds_read_b64_tr_b16 a[12:13], v234 offset:2048
    ds_read_b64_tr_b16 a[14:15], v235 offset:3072
    ds_read_b64_tr_b16 a[16:17], v232 offset:4096
    ds_read_b64_tr_b16 a[18:19], v233 offset:5120
    ds_read_b64_tr_b16 a[20:21], v234 offset:4096
    ds_read_b64_tr_b16 a[22:23], v235 offset:5120
    ds_read_b64_tr_b16 a[24:25], v232 offset:6144
    ds_read_b64_tr_b16 a[26:27], v233 offset:7168
    ds_read_b64_tr_b16 a[28:29], v234 offset:6144
    ds_read_b64_tr_b16 a[30:31], v235 offset:7168
    ds_read_b64_tr_b16 a[32:33], v232 offset:8192
    ds_read_b64_tr_b16 a[34:35], v233 offset:9216
    ds_read_b64_tr_b16 a[36:37], v234 offset:8192
    ds_read_b64_tr_b16 a[38:39], v235 offset:9216
    ds_read_b64_tr_b16 a[40:41], v232 offset:10240
    ds_read_b64_tr_b16 a[42:43], v233 offset:11264
    ds_read_b64_tr_b16 a[44:45], v234 offset:10240
    ds_read_b64_tr_b16 a[46:47], v235 offset:11264
    ds_read_b64_tr_b16 a[48:49], v232 offset:12288
    ds_read_b64_tr_b16 a[50:51], v233 offset:13312
    ds_read_b64_tr_b16 a[52:53], v234 offset:12288
    ds_read_b64_tr_b16 a[54:55], v235 offset:13312
    ds_read_b64_tr_b16 a[56:57], v232 offset:14336
    ds_read_b64_tr_b16 a[58:59], v233 offset:15360
    ds_read_b64_tr_b16 a[60:61], v234 offset:14336
    ds_read_b64_tr_b16 a[62:63], v235 offset:15360
    s_mov_b32 s97, 0x80000
L_rc15:
    s_waitcnt vmcnt(2)
    v_cmp_ne_u32 vcc, 1, v12
    s_cbranch_vccz L_rcx15
    s_sleep 1
    buffer_load_dword v12, v14, s[36:39], s62 offen sc1
    s_sub_u32 s97, s97, 1
    s_waitcnt vmcnt(0)
    s_cbranch_scc0 L_rc15
L_rcx15:
    buffer_load_dwordx4 v[96:99], v3, s[36:39], s56 offen offset:0 sc1
    buffer_load_dwordx4 v[100:103], v3, s[36:39], s56 offen offset:1024 sc1
    buffer_load_dwordx4 v[104:107], v3, s[36:39], s56 offen offset:2048 sc1
    buffer_load_dwordx4 v[108:111], v3, s[36:39], s56 offen offset:3072 sc1
    s_add_u32 s56, s56, 4096
    s_cmp_eq_u32 s56, s59
    s_cselect_b32 s56, s58, s56
    s_waitcnt vmcnt(4)
    s_barrier
    s_cmp_eq_u32 s3, 3
    s_cbranch_scc0 L_w3_16
    s_cmp_ge_u32 s88, 14
    s_cbranch_scc1 L_nof1
    s_lshl_b32 s87, s1, 7
    s_add_u32 s87, s87, 17842176
    s_mov_b64 exec, 1
    v_mov_b32 v252, 0
    v_mov_b32 v253, 1
    buffer_store_dword v253, v252, s[36:39], s87 offen sc1
    s_mov_b64 exec, -1
L_nof1:
L_w3_16:
    buffer_load_dwordx4 v[112:115], v3, s[36:39], s56 offen offset:0 sc1
    buffer_load_dwordx4 v[116:119], v3, s[36:39], s56 offen offset:1024 sc1
    buffer_load_dwordx4 v[120:123], v3, s[36:39], s56 offen offset:2048 sc1
    buffer_load_dwordx4 v[124:127], v3, s[36:39], s56 offen offset:3072 sc1
    s_add_u32 s56, s56, 4096
    s_cmp_eq_u32 s56, s59
    s_cselect_b32 s56, s58, s56
    buffer_load_dwordx4 v[128:131], v3, s[36:39], s56 offen offset:0 sc1
    buffer_load_dwordx4 v[132:135], v3, s[36:39], s56 offen offset:1024 sc1
    buffer_load_dwordx4 v[136:139], v3, s[36:39], s56 offen offset:2048 sc1
    buffer_load_dwordx4 v[140:143], v3, s[36:39], s56 offen offset:3072 sc1
    s_add_u32 s56, s56, 4096
    s_cmp_eq_u32 s56, s59
    s_cselect_b32 s56, s58, s56
    s_add_u32 s98, s91, 6
    s_add_u32 m0, s89, 65536
    s_cmp_ge_u32 s98, 7
    s_cselect_b32 s86, 7, 0
    s_sub_u32 s98, s98, s86
    s_lshl_b32 s86, s98, 16
    s_add_u32 s86, s86, s90
    buffer_load_dwordx4 v228, s[24:27], s86 offen offset:0 lds
    buffer_load_dwordx4 v229, s[24:27], s86 offen offset:1024 lds
    buffer_load_dwordx4 v230, s[24:27], s86 offen offset:2048 lds
    buffer_load_dwordx4 v231, s[24:27], s86 offen offset:3072 lds
    s_add_u32 m0, m0, 4096
    s_add_u32 s86, s86, 32768
    buffer_load_dwordx4 v228, s[24:27], s86 offen offset:0 lds
    buffer_load_dwordx4 v229, s[24:27], s86 offen offset:1024 lds
    buffer_load_dwordx4 v230, s[24:27], s86 offen offset:2048 lds
    buffer_load_dwordx4 v231, s[24:27], s86 offen offset:3072 lds
    ds_read_b128 v[16:19], v5 offset:0
    ds_read_b128 v[20:23], v5 offset:32
    v_add_u32 v7, s89, v6
    s_xor_b32 s60, s3, 1
    s_lshl_b32 s60, s60, 14
    v_add_u32 v9, s60, v6
    s_xor_b32 s60, s3, 2
    s_lshl_b32 s60, s60, 14
    v_add_u32 v10, s60, v6
    s_xor_b32 s60, s3, 3
    s_lshl_b32 s60, s60, 14
    v_add_u32 v11, s60, v6
    v_and_b32 v8, 31, v2
    v_lshlrev_b32 v8, 10, v8
    v_lshrrev_b32 v5, 5, v2
    v_lshl_add_u32 v8, v5, 4, v8
    s_lshl_b32 s61, s54, 15
    s_lshl_b32 s60, s93, 7
    s_add_u32 s61, s61, s60
    s_lshl_b32 s60, s3, 5
    s_add_u32 s61, s61, s60
    s_add_u32 s60, s61, 65536
    s_waitcnt vmcnt(19)
    v_mfma_f32_32x32x16_bf16 v[32:47], a[128:131], v[96:99], 0
    buffer_load_dwordx4 v[144:147], v3, s[36:39], s56 offen offset:0 sc1
    v_mfma_f32_32x32x16_bf16 v[64:79], a[132:135], v[96:99], 0
    buffer_load_dwordx4 v[148:151], v3, s[36:39], s56 offen offset:1024 sc1
    s_waitcnt vmcnt(20)
    v_mfma_f32_32x32x16_bf16 v[32:47], a[136:139], v[100:103], v[32:47]
    buffer_load_dwordx4 v[152:155], v3, s[36:39], s56 offen offset:2048 sc1
    v_mfma_f32_32x32x16_bf16 v[64:79], a[140:143], v[100:103], v[64:79]
    s_waitcnt vmcnt(20)
    v_mfma_f32_32x32x16_bf16 v[32:47], a[144:147], v[104:107], v[32:47]
    buffer_load_dwordx4 v[156:159], v3, s[36:39], s56 offen offset:3072 sc1
    s_add_u32 s56, s56, 4096
    s_cmp_eq_u32 s56, s59
    s_cselect_b32 s56, s58, s56
    v_mfma_f32_32x32x16_bf16 v[64:79], a[148:151], v[104:107], v[64:79]
    buffer_load_dwordx4 v[160:163], v3, s[36:39], s56 offen offset:0 sc1
    s_waitcnt vmcnt(21)
    v_mfma_f32_32x32x16_bf16 v[32:47], a[152:155], v[108:111], v[32:47]
    buffer_load_dwordx4 v[164:167], v3, s[36:39], s56 offen offset:1024 sc1
    v_mfma_f32_32x32x16_bf16 v[64:79], a[156:159], v[108:111], v[64:79]
    s_waitcnt vmcnt(21)
    v_mfma_f32_32x32x16_bf16 v[32:47], a[160:163], v[112:115], v[32:47]
    buffer_load_dwordx4 v[168:171], v3, s[36:39], s56 offen offset:2048 sc1
    v_mfma_f32_32x32x16_bf16 v[64:79], a[164:167], v[112:115], v[64:79]
    buffer_load_dwordx4 v[172:175], v3, s[36:39], s56 offen offset:3072 sc1
    s_add_u32 s56, s56, 4096
    s_cmp_eq_u32 s56, s59
    s_cselect_b32 s56, s58, s56
    s_waitcnt vmcnt(22)
    v_mfma_f32_32x32x16_bf16 v[32:47], a[168:171], v[116:119], v[32:47]
    buffer_load_dwordx4 v[176:179], v3, s[36:39], s56 offen offset:0 sc1
    v_mfma_f32_32x32x16_bf16 v[64:79], a[172:175], v[116:119], v[64:79]
    s_waitcnt vmcnt(22)
    v_mfma_f32_32x32x16_bf16 v[32:47], a[176:179], v[120:123], v[32:47]
    buffer_load_dwordx4 v[180:183], v3, s[36:39], s56 offen offset:1024 sc1
    buffer_load_dword v13, v14, s[36:39], s63 offen sc1
    v_mfma_f32_32x32x16_bf16 v[64:79], a[180:183], v[120:123], v[64:79]
    buffer_load_dwordx4 v[184:187], v3, s[36:39], s56 offen offset:2048 sc1
    s_waitcnt vmcnt(24)
    v_mfma_f32_32x32x16_bf16 v[32:47], a[184:187], v[124:127], v[32:47]
    buffer_load_dwordx4 v[188:191], v3, s[36:39], s56 offen offset:3072 sc1
    s_add_u32 s56, s56, 4096
    s_cmp_eq_u32 s56, s59
    s_cselect_b32 s56, s58, s56
    v_mfma_f32_32x32x16_bf16 v[64:79], a[188:191], v[124:127], v[64:79]
    s_waitcnt vmcnt(13)
    v_add_u32 v232, 0x10000, v232
    v_add_u32 v233, 0x10000, v233
    v_add_u32 v234, 0x10000, v234
    v_add_u32 v235, 0x10000, v235
    ds_read_b64_tr_b16 a[64:65], v232 offset:0
    ds_read_b64_tr_b16 a[66:67], v233 offset:1024
    ds_read_b64_tr_b16 a[68:69], v234 offset:0
    ds_read_b64_tr_b16 a[70:71], v235 offset:1024
    ds_read_b64_tr_b16 a[72:73], v232 offset:2048
    ds_read_b64_tr_b16 a[74:75], v233 offset:3072
    ds_read_b64_tr_b16 a[76:77], v234 offset:2048
    ds_read_b64_tr_b16 a[78:79], v235 offset:3072
    ds_read_b64_tr_b16 a[80:81], v232 offset:4096
    ds_read_b64_tr_b16 a[82:83], v233 offset:5120
    ds_read_b64_tr_b16 a[84:85], v234 offset:4096
    ds_read_b64_tr_b16 a[86:87], v235 offset:5120
    ds_read_b64_tr_b16 a[88:89], v232 offset:6144
    ds_read_b64_tr_b16 a[90:91], v233 offset:7168
    ds_read_b64_tr_b16 a[92:93], v234 offset:6144
    ds_read_b64_tr_b16 a[94:95], v235 offset:7168
    v_mfma_f32_32x32x16_bf16 v[32:47], a[192:195], v[128:131], v[32:47]
    buffer_load_dwordx4 v[192:195], v3, s[36:39], s56 offen offset:0 sc1
    v_mfma_f32_32x32x16_bf16 v[64:79], a[196:199], v[128:131], v[64:79]
    buffer_load_dwordx4 v[196:199], v3, s[36:39], s56 offen offset:1024 sc1
    v_mfma_f32_32x32x16_bf16 v[32:47], a[200:203], v[132:135], v[32:47]
    buffer_load_dwordx4 v[200:203], v3, s[36:39], s56 offen offset:2048 sc1
    v_mfma_f32_32x32x16_bf16 v[64:79], a[204:207], v[132:135], v[64:79]
    v_mfma_f32_32x32x16_bf16 v[32:47], a[208:211], v[136:139], v[32:47]
    buffer_load_dwordx4 v[204:207], v3, s[36:39], s56 offen offset:3072 sc1
    s_add_u32 s56, s56, 4096
    s_cmp_eq_u32 s56, s59
    s_cselect_b32 s56, s58, s56
    v_mfma_f32_32x32x16_bf16 v[64:79], a[212:215], v[136:139], v[64:79]
    v_mfma_f32_32x32x16_bf16 v[32:47], a[216:219], v[140:143], v[32:47]
    v_mfma_f32_32x32x16_bf16 v[64:79], a[220:223], v[140:143], v[64:79]
    s_waitcnt vmcnt(16)
    v_mfma_f32_32x32x16_bf16 v[32:47], a[224:227], v[144:147], v[32:47]
    v_mfma_f32_32x32x16_bf16 v[64:79], a[228:231], v[144:147], v[64:79]
    s_waitcnt vmcnt(15)
    v_mfma_f32_32x32x16_bf16 v[32:47], a[232:235], v[148:151], v[32:47]
    v_mfma_f32_32x32x16_bf16 v[64:79], a[236:239], v[148:151], v[64:79]
    s_mov_b32 s97, 0x80000
L_rc17:
    s_waitcnt vmcnt(6)
    v_cmp_ne_u32 vcc, 1, v13
    s_cbranch_vccz L_rcx17
    s_sleep 1
    buffer_load_dword v13, v14, s[36:39], s63 offen sc1
    s_sub_u32 s97, s97, 1
    s_waitcnt vmcnt(0)
    s_cbranch_scc0 L_rc17
L_rcx17:
    buffer_load_dwordx4 v[208:211], v4, s[36:39], s56 offen offset:0 sc1
    buffer_load_dwordx4 v[212:215], v4, s[36:39], s56 offen offset:1024 sc1
    v_mfma_f32_32x32x16_bf16 v[32:47], a[240:243], v[152:155], v[32:47]
    buffer_load_dwordx4 v[216:219], v4, s[36:39], s56 offen offset:2048 sc1
    buffer_load_dwordx4 v[220:223], v4, s[36:39], s56 offen offset:3072 sc1
    s_add_u32 s56, s56, 4096
    s_cmp_eq_u32 s56, s59
    s_cselect_b32 s56, s58, s56
    v_mfma_f32_32x32x16_bf16 v[64:79], a[244:247], v[152:155], v[64:79]
    buffer_load_dwordx4 v[96:99], v4, s[36:39], s56 offen offset:0 sc1
    buffer_load_dwordx4 v[100:103], v4, s[36:39], s56 offen offset:1024 sc1
    v_mfma_f32_32x32x16_bf16 v[32:47], a[248:251], v[156:159], v[32:47]
    buffer_load_dwordx4 v[104:107], v4, s[36:39], s56 offen offset:2048 sc1
    buffer_load_dwordx4 v[108:111], v4, s[36:39], s56 offen offset:3072 sc1
    s_add_u32 s56, s56, 4096
    s_cmp_eq_u32 s56, s59
    s_cselect_b32 s56, s58, s56
    v_mfma_f32_32x32x16_bf16 v[64:79], a[252:255], v[156:159], v[64:79]
    buffer_load_dwordx4 v[112:115], v4, s[36:39], s56 offen offset:0 sc1
    buffer_load_dwordx4 v[116:119], v4, s[36:39], s56 offen offset:1024 sc1
    s_waitcnt lgkmcnt(15)
    v_mfma_f32_32x32x16_bf16 v[32:47], a[0:3], v[160:163], v[32:47]
    buffer_load_dwordx4 v[120:123], v4, s[36:39], s56 offen offset:2048 sc1
    buffer_load_dwordx4 v[124:127], v4, s[36:39], s56 offen offset:3072 sc1
    s_add_u32 s56, s56, 4096
    s_cmp_eq_u32 s56, s59
    s_cselect_b32 s56, s58, s56
    v_mfma_f32_32x32x16_bf16 v[64:79], a[4:7], v[160:163], v[64:79]
    v_mfma_f32_32x32x16_bf16 v[32:47], a[8:11], v[164:167], v[32:47]
    buffer_load_dwordx4 v[128:131], v4, s[36:39], s56 offen offset:0 sc1
    v_mfma_f32_32x32x16_bf16 v[64:79], a[12:15], v[164:167], v[64:79]
    v_mfma_f32_32x32x16_bf16 v[32:47], a[16:19], v[168:171], v[32:47]
    buffer_load_dwordx4 v[132:135], v4, s[36:39], s56 offen offset:1024 sc1
    v_mfma_f32_32x32x16_bf16 v[64:79], a[20:23], v[168:171], v[64:79]
    v_mfma_f32_32x32x16_bf16 v[32:47], a[24:27], v[172:175], v[32:47]
    buffer_load_dwordx4 v[136:139], v4, s[36:39], s56 offen offset:2048 sc1
    v_mfma_f32_32x32x16_bf16 v[64:79], a[28:31], v[172:175], v[64:79]
    v_mfma_f32_32x32x16_bf16 v[32:47], a[32:35], v[176:179], v[32:47]
    buffer_load_dwordx4 v[140:143], v4, s[36:39], s56 offen offset:3072 sc1
    s_add_u32 s56, s56, 4096
    s_cmp_eq_u32 s56, s59
    s_cselect_b32 s56, s58, s56
    v_mfma_f32_32x32x16_bf16 v[64:79], a[36:39], v[176:179], v[64:79]
    v_mfma_f32_32x32x16_bf16 v[32:47], a[40:43], v[180:183], v[32:47]
    buffer_load_dwordx4 v[144:147], v4, s[36:39], s56 offen offset:0 sc1
    v_mfma_f32_32x32x16_bf16 v[64:79], a[44:47], v[180:183], v[64:79]
    s_waitcnt vmcnt(22)
    v_mfma_f32_32x32x16_bf16 v[32:47], a[48:51], v[184:187], v[32:47]
    buffer_load_dwordx4 v[148:151], v4, s[36:39], s56 offen offset:1024 sc1
    v_mfma_f32_32x32x16_bf16 v[64:79], a[52:55], v[184:187], v[64:79]
    s_waitcnt vmcnt(22)
    v_mfma_f32_32x32x16_bf16 v[32:47], a[56:59], v[188:191], v[32:47]
    buffer_load_dwordx4 v[152:155], v4, s[36:39], s56 offen offset:2048 sc1
    v_mfma_f32_32x32x16_bf16 v[64:79], a[60:63], v[188:191], v[64:79]
    s_waitcnt vmcnt(22) lgkmcnt(14)
    v_mfma_f32_32x32x16_bf16 v[32:47], a[64:67], v[192:195], v[32:47]
    buffer_load_dwordx4 v[156:159], v4, s[36:39], s56 offen offset:3072 sc1
    s_add_u32 s56, s56, 4096
    s_cmp_eq_u32 s56, s59
    s_cselect_b32 s56, s58, s56
    s_waitcnt lgkmcnt(12)
    v_mfma_f32_32x32x16_bf16 v[64:79], a[68:71], v[192:195], v[64:79]
    s_waitcnt vmcnt(22) lgkmcnt(10)
    v_mfma_f32_32x32x16_bf16 v[32:47], a[72:75], v[196:199], v[32:47]
    buffer_load_dwordx4 v[160:163], v4, s[36:39], s56 offen offset:0 sc1
    s_waitcnt lgkmcnt(8)
    v_mfma_f32_32x32x16_bf16 v[64:79], a[76:79], v[196:199], v[64:79]
    s_waitcnt vmcnt(22) lgkmcnt(6)
    v_mfma_f32_32x32x16_bf16 v[32:47], a[80:83], v[200:203], v[32:47]
    buffer_load_dwordx4 v[164:167], v4, s[36:39], s56 offen offset:1024 sc1
    s_waitcnt lgkmcnt(4)
    v_mfma_f32_32x32x16_bf16 v[64:79], a[84:87], v[200:203], v[64:79]
    s_waitcnt vmcnt(22) lgkmcnt(2)
    v_mfma_f32_32x32x16_bf16 v[32:47], a[88:91], v[204:207], v[32:47]
    buffer_load_dwordx4 v[168:171], v4, s[36:39], s56 offen offset:2048 sc1
    s_waitcnt lgkmcnt(0)
    v_mfma_f32_32x32x16_bf16 v[64:79], a[92:95], v[204:207], v[64:79]
    s_waitcnt vmcnt(22)
    v_mfma_f32_32x32x16_bf16 v[48:63], a[128:131], v[208:211], 0
    buffer_load_dwordx4 v[172:175], v4, s[36:39], s56 offen offset:3072 sc1
    s_add_u32 s56, s56, 4096
    s_cmp_eq_u32 s56, s59
    s_cselect_b32 s56, s58, s56
    v_mfma_f32_32x32x16_bf16 v[80:95], a[132:135], v[208:211], 0
    s_waitcnt vmcnt(22)
    v_mfma_f32_32x32x16_bf16 v[48:63], a[136:139], v[212:215], v[48:63]
    buffer_load_dwordx4 v[176:179], v4, s[36:39], s56 offen offset:0 sc1
    v_mfma_f32_32x32x16_bf16 v[80:95], a[140:143], v[212:215], v[80:95]
    s_waitcnt vmcnt(22)
    v_mfma_f32_32x32x16_bf16 v[48:63], a[144:147], v[216:219], v[48:63]
    buffer_load_dwordx4 v[180:183], v4, s[36:39], s56 offen offset:1024 sc1
    ds_write_b128 v7, v[40:43] offset:0
    ds_write_b128 v7, v[44:47] offset:1024
    v_mfma_f32_32x32x16_bf16 v[80:95], a[148:151], v[216:219], v[80:95]
    ds_write_b128 v7, v[64:67] offset:2048
    ds_write_b128 v7, v[68:71] offset:3072
    s_waitcnt vmcnt(22)
    v_mfma_f32_32x32x16_bf16 v[48:63], a[152:155], v[220:223], v[48:63]
    buffer_load_dwordx4 v[184:187], v4, s[36:39], s56 offen offset:2048 sc1
    ds_write_b128 v7, v[72:75] offset:4096
    ds_write_b128 v7, v[76:79] offset:5120
    v_mfma_f32_32x32x16_bf16 v[80:95], a[156:159], v[220:223], v[80:95]
    s_waitcnt vmcnt(22)
    v_mfma_f32_32x32x16_bf16 v[48:63], a[160:163], v[96:99], v[48:63]
    buffer_load_dwordx4 v[188:191], v4, s[36:39], s56 offen offset:3072 sc1
    s_add_u32 s56, s56, 4096
    s_cmp_eq_u32 s56, s59
    s_cselect_b32 s56, s58, s56
    v_mfma_f32_32x32x16_bf16 v[80:95], a[164:167], v[96:99], v[80:95]
    s_waitcnt vmcnt(22)
    v_mfma_f32_32x32x16_bf16 v[48:63], a[168:171], v[100:103], v[48:63]
    v_mfma_f32_32x32x16_bf16 v[80:95], a[172:175], v[100:103], v[80:95]
    s_waitcnt lgkmcnt(0)
    s_barrier
    s_waitcnt vmcnt(21)
    v_mfma_f32_32x32x16_bf16 v[48:63], a[176:179], v[104:107], v[48:63]
    ds_read_b128 v[40:43], v9 offset:0
    ds_read_b128 v[44:47], v9 offset:1024
    v_mfma_f32_32x32x16_bf16 v[80:95], a[180:183], v[104:107], v[80:95]
    ds_read_b128 v[64:67], v10 offset:2048
    ds_read_b128 v[68:71], v10 offset:3072
    s_waitcnt vmcnt(20)
    v_mfma_f32_32x32x16_bf16 v[48:63], a[184:187], v[108:111], v[48:63]
    ds_read_b128 v[72:75], v11 offset:4096
    ds_read_b128 v[76:79], v11 offset:5120
    v_mfma_f32_32x32x16_bf16 v[80:95], a[188:191], v[108:111], v[80:95]
    v_lshlrev_b32 v24, 16, v236
    v_and_b32 v25, 0xffff0000, v236
    s_waitcnt vmcnt(19)
    v_mfma_f32_32x32x16_bf16 v[48:63], a[192:195], v[112:115], v[48:63]
    v_lshlrev_b32 v26, 16, v237
    v_and_b32 v27, 0xffff0000, v237
    v_mfma_f32_32x32x16_bf16 v[80:95], a[196:199], v[112:115], v[80:95]
    v_lshlrev_b32 v28, 16, v238
    v_and_b32 v29, 0xffff0000, v238
    s_waitcnt vmcnt(18)
    v_mfma_f32_32x32x16_bf16 v[48:63], a[200:203], v[116:119], v[48:63]
    v_lshlrev_b32 v30, 16, v239
    v_and_b32 v31, 0xffff0000, v239
    v_mfma_f32_32x32x16_bf16 v[80:95], a[204:207], v[116:119], v[80:95]
    s_waitcnt lgkmcnt(5)
    v_add_f32 v32, v32, v40
    v_add_f32 v33, v33, v41
    s_waitcnt vmcnt(17)
    v_mfma_f32_32x32x16_bf16 v[48:63], a[208:211], v[120:123], v[48:63]
    v_add_f32 v34, v34, v42
    v_add_f32 v35, v35, v43
    v_mfma_f32_32x32x16_bf16 v[80:95], a[212:215], v[120:123], v[80:95]
    s_waitcnt lgkmcnt(4)
    v_add_f32 v36, v36, v44
    v_add_f32 v37, v37, v45
    s_waitcnt vmcnt(16)
    v_mfma_f32_32x32x16_bf16 v[48:63], a[216:219], v[124:127], v[48:63]
    v_add_f32 v38, v38, v46
    v_add_f32 v39, v39, v47
    v_mfma_f32_32x32x16_bf16 v[80:95], a[220:223], v[124:127], v[80:95]
    s_waitcnt lgkmcnt(3)
    v_add_f32 v32, v32, v64
    v_add_f32 v33, v33, v65
    s_waitcnt vmcnt(15)
    v_mfma_f32_32x32x16_bf16 v[48:63], a[224:227], v[128:131], v[48:63]
    v_add_f32 v34, v34, v66
    v_add_f32 v35, v35, v67
    v_mfma_f32_32x32x16_bf16 v[80:95], a[228:231], v[128:131], v[80:95]
    s_waitcnt lgkmcnt(2)
    v_add_f32 v36, v36, v68
    v_add_f32 v37, v37, v69
    s_waitcnt vmcnt(14)
    v_mfma_f32_32x32x16_bf16 v[48:63], a[232:235], v[132:135], v[48:63]
    v_add_f32 v38, v38, v70
    v_add_f32 v39, v39, v71
    v_mfma_f32_32x32x16_bf16 v[80:95], a[236:239], v[132:135], v[80:95]
    s_waitcnt lgkmcnt(1)
    v_add_f32 v32, v32, v72
    v_add_f32 v33, v33, v73
    s_waitcnt vmcnt(13)
    v_mfma_f32_32x32x16_bf16 v[48:63], a[240:243], v[136:139], v[48:63]
    v_add_f32 v34, v34, v74
    v_add_f32 v35, v35, v75
    v_mfma_f32_32x32x16_bf16 v[80:95], a[244:247], v[136:139], v[80:95]
    s_waitcnt lgkmcnt(0)
    v_add_f32 v36, v36, v76
    v_add_f32 v37, v37, v77
    s_waitcnt vmcnt(12)
    v_mfma_f32_32x32x16_bf16 v[48:63], a[248:251], v[140:143], v[48:63]
    v_add_f32 v38, v38, v78
    v_add_f32 v39, v39, v79
    v_mfma_f32_32x32x16_bf16 v[80:95], a[252:255], v[140:143], v[80:95]
    v_fma_f32 v32, v32, v16, v24
    v_fma_f32 v33, v33, v17, v25
    s_waitcnt vmcnt(11)
    v_mfma_f32_32x32x16_bf16 v[48:63], a[0:3], v[144:147], v[48:63]
    v_fma_f32 v34, v34, v18, v26
    v_fma_f32 v35, v35, v19, v27
    v_mfma_f32_32x32x16_bf16 v[80:95], a[4:7], v[144:147], v[80:95]
    v_fma_f32 v36, v36, v20, v28
    v_fma_f32 v37, v37, v21, v29
    s_waitcnt vmcnt(10)
    v_mfma_f32_32x32x16_bf16 v[48:63], a[8:11], v[148:151], v[48:63]
    v_fma_f32 v38, v38, v22, v30
    v_fma_f32 v39, v39, v23, v31
    v_mfma_f32_32x32x16_bf16 v[80:95], a[12:15], v[148:151], v[80:95]
    v_cvt_pk_bf16_f32 v40, v32, v33
    v_cvt_pk_bf16_f32 v41, v34, v35
    s_waitcnt vmcnt(9)
    v_mfma_f32_32x32x16_bf16 v[48:63], a[16:19], v[152:155], v[48:63]
    v_cvt_pk_bf16_f32 v42, v36, v37
    v_cvt_pk_bf16_f32 v43, v38, v39
    v_mfma_f32_32x32x16_bf16 v[80:95], a[20:23], v[152:155], v[80:95]
    v_permlane32_swap_b32 v40, v42
    v_permlane32_swap_b32 v41, v43
    s_waitcnt vmcnt(8)
    v_mfma_f32_32x32x16_bf16 v[48:63], a[24:27], v[156:159], v[48:63]
    buffer_store_dwordx4 v[40:43], v8, s[32:35], s61 offen
    v_mfma_f32_32x32x16_bf16 v[80:95], a[28:31], v[156:159], v[80:95]
    s_waitcnt vmcnt(8)
    v_mfma_f32_32x32x16_bf16 v[48:63], a[32:35], v[160:163], v[48:63]
    v_mfma_f32_32x32x16_bf16 v[80:95], a[36:39], v[160:163], v[80:95]
    s_waitcnt vmcnt(7)
    v_mfma_f32_32x32x16_bf16 v[48:63], a[40:43], v[164:167], v[48:63]
    v_mfma_f32_32x32x16_bf16 v[80:95], a[44:47], v[164:167], v[80:95]
    s_waitcnt vmcnt(6)
    v_mfma_f32_32x32x16_bf16 v[48:63], a[48:51], v[168:171], v[48:63]
    v_mfma_f32_32x32x16_bf16 v[80:95], a[52:55], v[168:171], v[80:95]
    s_waitcnt vmcnt(5)
    v_mfma_f32_32x32x16_bf16 v[48:63], a[56:59], v[172:175], v[48:63]
    v_mfma_f32_32x32x16_bf16 v[80:95], a[60:63], v[172:175], v[80:95]
    s_waitcnt vmcnt(4)
    v_mfma_f32_32x32x16_bf16 v[48:63], a[64:67], v[176:179], v[48:63]
    v_mfma_f32_32x32x16_bf16 v[80:95], a[68:71], v[176:179], v[80:95]
    s_waitcnt vmcnt(3)
    v_mfma_f32_32x32x16_bf16 v[48:63], a[72:75], v[180:183], v[48:63]
    v_mfma_f32_32x32x16_bf16 v[80:95], a[76:79], v[180:183], v[80:95]
    s_waitcnt vmcnt(2)
    v_mfma_f32_32x32x16_bf16 v[48:63], a[80:83], v[184:187], v[48:63]
    v_mfma_f32_32x32x16_bf16 v[80:95], a[84:87], v[184:187], v[80:95]
    s_waitcnt vmcnt(1)
    v_mfma_f32_32x32x16_bf16 v[48:63], a[88:91], v[188:191], v[48:63]
    v_mfma_f32_32x32x16_bf16 v[80:95], a[92:95], v[188:191], v[80:95]
    s_nop 10
    ds_write_b128 v7, v[56:59] offset:6144
    ds_write_b128 v7, v[60:63] offset:7168
    ds_write_b128 v7, v[80:83] offset:8192
    ds_write_b128 v7, v[84:87] offset:9216
    ds_write_b128 v7, v[88:91] offset:10240
    ds_write_b128 v7, v[92:95] offset:11264
    s_waitcnt lgkmcnt(0)
    s_barrier
    ds_read_b128 v[96:99], v9 offset:6144
    ds_read_b128 v[100:103], v9 offset:7168
    ds_read_b128 v[104:107], v10 offset:8192
    ds_read_b128 v[108:111], v10 offset:9216
    ds_read_b128 v[112:115], v11 offset:10240
    ds_read_b128 v[116:119], v11 offset:11264
    v_lshlrev_b32 v24, 16, v240
    v_and_b32 v25, 0xffff0000, v240
    v_lshlrev_b32 v26, 16, v241
    v_and_b32 v27, 0xffff0000, v241
    v_lshlrev_b32 v28, 16, v242
    v_and_b32 v29, 0xffff0000, v242
    v_lshlrev_b32 v30, 16, v243
    v_and_b32 v31, 0xffff0000, v243
    s_waitcnt lgkmcnt(5)
    v_pk_add_f32 v[48:49], v[48:49], v[96:97]
    v_pk_add_f32 v[50:51], v[50:51], v[98:99]
    s_waitcnt lgkmcnt(4)
    v_pk_add_f32 v[52:53], v[52:53], v[100:101]
    v_pk_add_f32 v[54:55], v[54:55], v[102:103]
    s_waitcnt lgkmcnt(3)
    v_pk_add_f32 v[48:49], v[48:49], v[104:105]
    v_pk_add_f32 v[50:51], v[50:51], v[106:107]
    s_waitcnt lgkmcnt(2)
    v_pk_add_f32 v[52:53], v[52:53], v[108:109]
    v_pk_add_f32 v[54:55], v[54:55], v[110:111]
    s_waitcnt lgkmcnt(1)
    v_pk_add_f32 v[48:49], v[48:49], v[112:113]
    v_pk_add_f32 v[50:51], v[50:51], v[114:115]
    s_waitcnt lgkmcnt(0)
    v_pk_add_f32 v[52:53], v[52:53], v[116:117]
    v_pk_add_f32 v[54:55], v[54:55], v[118:119]
    v_pk_fma_f32 v[48:49], v[48:49], v[16:17], v[24:25]
    v_pk_fma_f32 v[50:51], v[50:51], v[18:19], v[26:27]
    v_pk_fma_f32 v[52:53], v[52:53], v[20:21], v[28:29]
    v_pk_fma_f32 v[54:55], v[54:55], v[22:23], v[30:31]
    v_cvt_pk_bf16_f32 v96, v48, v49
    v_cvt_pk_bf16_f32 v97, v50, v51
    v_cvt_pk_bf16_f32 v98, v52, v53
    v_cvt_pk_bf16_f32 v99, v54, v55
    s_nop 0
    v_permlane32_swap_b32 v96, v98
    v_permlane32_swap_b32 v97, v99
    buffer_store_dwordx4 v[96:99], v8, s[32:35], s60 offen
L_end:
    s_endpgm
.section .rodata,"a"
.p2align 6
.amdhsa_kernel adaLN_cond__ssm_conv_h3__dense_activation_silu__prompt_kernel
  .amdhsa_next_free_vgpr 512
  .amdhsa_next_free_sgpr 102
  .amdhsa_accum_offset 256
  .amdhsa_group_segment_fixed_size 0
  .amdhsa_kernarg_size 112
  .amdhsa_user_sgpr_count 2
  .amdhsa_user_sgpr_kernarg_segment_ptr 1
  .amdhsa_system_sgpr_workgroup_id_x 1
  .amdhsa_float_denorm_mode_32 3
.end_amdhsa_kernel
```
